```python
import torch

def _softmax(x, axis=-1):
    return torch.softmax(x, dim=axis)
def _gelu(x):
    return torch.nn.functional.gelu(x, approximate="tanh")
def _silu(x):
    return torch.nn.functional.silu(x)
def _sigmoid(x):
    return torch.sigmoid(x)
def _layernorm(x, axis=-1, eps=1e-5):
    m = x.mean(dim=axis, keepdim=True)
    v = x.var(dim=axis, keepdim=True, unbiased=False)
    return (x - m) / torch.sqrt(v + eps)
def _scatter_add(tgt, idx, src, axis=0):
    return tgt.clone().index_add_(axis, idx, src)
def _segment_sum(src, seg, n):
    out = torch.zeros((n,) + src.shape[1:], dtype=src.dtype)
    return out.index_add_(0, seg, src)
def _pad(x, pw):
    flat = tuple(v for pair in reversed(pw) for v in pair)
    return torch.nn.functional.pad(x, flat)

kernel_name = 'concat_heads__gqa_block_cached__gqa_block_cached__near_ridge'

def setup_inputs():

    _w = (lambda a: (lambda t: t.to(torch.bfloat16) if t.is_floating_point() else t)(torch.as_tensor(a)))
    def _A_setup():
        B, Sq, D = 8, 80, 576
        Hq, Hkv, Sk, Dh = 32, 16, 1024, 128
        assert Hq % Hkv == 0, (Hq, Hkv)
        return {
            "x": _w((lambda *s: torch.randn(*s, dtype=torch.bfloat16) * 0.8)(B, Sq, D)),
            "k_cache": _w((lambda *s: torch.randn(*s, dtype=torch.bfloat16) * 0.8)(B, Hkv, Sk, Dh)),
            "v_cache": _w((lambda *s: torch.randn(*s, dtype=torch.bfloat16) * 0.05)(B, Hkv, Sk, Dh)),
            "wq": _w((lambda *s: torch.randn(*s, dtype=torch.bfloat16) * 0.8)(D, Hq * Dh) * (D ** -0.5)),
            "wo": _w((lambda *s: torch.randn(*s, dtype=torch.bfloat16) * 0.05)(Hq * Dh, D) * ((Hq * Dh) ** -0.5)),
        }
    _A_in = _A_setup()

    def _B_setup():
        B, Sq, D = 8, 80, 576
        Hq, Hkv, Sk, Dh = 32, 16, 1024, 128
        assert Hq % Hkv == 0, (Hq, Hkv)
        return {
            "x": _w((lambda *s: torch.randn(*s, dtype=torch.bfloat16) * 0.8)(B, Sq, D)),
            "k_cache": _w((lambda *s: torch.randn(*s, dtype=torch.bfloat16) * 0.8)(B, Hkv, Sk, Dh)),
            "v_cache": _w((lambda *s: torch.randn(*s, dtype=torch.bfloat16) * 0.05)(B, Hkv, Sk, Dh)),
            "wq": _w((lambda *s: torch.randn(*s, dtype=torch.bfloat16) * 0.8)(D, Hq * Dh) * (D ** -0.5)),
            "wo": _w((lambda *s: torch.randn(*s, dtype=torch.bfloat16) * 0.05)(Hq * Dh, D) * ((Hq * Dh) ** -0.5)),
        }
    _B_in = _B_setup()

    return {
        "A_x": _A_in["x"],
        "A_k_cache": _A_in["k_cache"],
        "A_v_cache": _A_in["v_cache"],
        "A_wq": _A_in["wq"],
        "A_wo": _A_in["wo"],
        "B_x": _B_in["x"],
        "B_k_cache": _B_in["k_cache"],
        "B_v_cache": _B_in["v_cache"],
        "B_wq": _B_in["wq"],
        "B_wo": _B_in["wo"],
    }

def reference(A_x, A_k_cache, A_v_cache, A_wq, A_wo, B_x, B_k_cache, B_v_cache, B_wq, B_wo):
    def _A_ref(x, k_cache, v_cache, wq, wo):
        B, Sq, D = x.shape
        Hq, Dh = 32, 128
        Hkv = k_cache.shape[1]
        rep = Hq // Hkv
        q = (lambda x, *d: x.permute(*d))((x @ wq).reshape(B, Sq, Hq, Dh), 0, 2, 1, 3)
        k = (lambda x, n, axis: torch.repeat_interleave(x, n, dim=axis))(k_cache, rep, axis=1)
        v = (lambda x, n, axis: torch.repeat_interleave(x, n, dim=axis))(v_cache, rep, axis=1)
        scores = torch.einsum("bhqd,bhkd->bhqk", q, k) * (Dh ** -0.5)
        p = _softmax(scores, axis=-1)
        o = torch.einsum("bhqk,bhkd->bhqd", p, v)
        return (lambda x, *d: x.permute(*d))(o, 0, 2, 1, 3).reshape(B, Sq, Hq * Dh) @ wo

    def _B_ref(x, k_cache, v_cache, wq, wo):
        B, Sq, D = x.shape
        Hq, Dh = 32, 128
        Hkv = k_cache.shape[1]
        rep = Hq // Hkv
        q = (lambda x, *d: x.permute(*d))((x @ wq).reshape(B, Sq, Hq, Dh), 0, 2, 1, 3)
        k = (lambda x, n, axis: torch.repeat_interleave(x, n, dim=axis))(k_cache, rep, axis=1)
        v = (lambda x, n, axis: torch.repeat_interleave(x, n, dim=axis))(v_cache, rep, axis=1)
        scores = torch.einsum("bhqd,bhkd->bhqk", q, k) * (Dh ** -0.5)
        p = _softmax(scores, axis=-1)
        o = torch.einsum("bhqk,bhkd->bhqd", p, v)
        return (lambda x, *d: x.permute(*d))(o, 0, 2, 1, 3).reshape(B, Sq, Hq * Dh) @ wo

    a = _A_ref(A_x, A_k_cache, A_v_cache, A_wq, A_wo)
    b = _B_ref(B_x, B_k_cache, B_v_cache, B_wq, B_wo)
    return torch.concatenate([a, b], axis=-1)
```

```asm
; @launch grid=(256,1,1) block=(256,1,1) lds=163840
.amdgcn_target "amdgcn-amd-amdhsa--gfx950"
.text
.globl concat_heads__gqa_block_cached__gqa_block_cached__near_ridge_kernel
.p2align 8
.type concat_heads__gqa_block_cached__gqa_block_cached__near_ridge_kernel,@function
concat_heads__gqa_block_cached__gqa_block_cached__near_ridge_kernel:
    s_cmp_ge_u32 s2, 256
    s_cbranch_scc1 L_end
    s_and_b32 s3, s2, 7
    s_lshr_b32 s4, s2, 3
    s_lshr_b32 s5, s4, 3
    s_lshl_b32 s3, s3, 2
    s_add_u32 s3, s3, s5
    s_and_b32 s4, s4, 7
    s_and_b32 s5, s3, 15
    s_lshr_b32 s3, s3, 4
    s_mul_i32 s6, s3, 40
    s_add_u32 s8, s0, s6
    s_addc_u32 s9, s1, 0
    s_load_dwordx2 s[16:17], s[8:9], 0
    s_load_dwordx2 s[20:21], s[8:9], 24
    s_load_dwordx2 s[12:13], s[8:9], 8
    s_load_dwordx2 s[44:45], s[8:9], 16
    s_load_dwordx2 s[24:25], s[8:9], 32
    s_load_dwordx2 s[28:29], s[0:1], 96
    v_lshrrev_b32 v4, 6, v0
    v_and_b32 v1, 63, v0
    v_readfirstlane_b32 s6, v4
    v_and_b32 v2, 15, v0
    v_lshrrev_b32 v3, 4, v1
    s_lshr_b32 s7, s6, 1
    s_and_b32 s8, s6, 1
    s_lshl_b32 s33, s6, 13

    s_getpc_b64 s[60:61]
L_pc0:
    s_and_b32 s61, s61, 0xffff
    s_mov_b32 s62, L_code_end-L_pc0
    s_mov_b32 s63, 0x20000
    s_lshl_b32 s9, s4, 2
    s_add_u32 s9, s9, s6
    s_lshl_b32 s9, s9, 7
    v_lshlrev_b32 v5, 12, v1
    s_mov_b64 exec, 0xff
    buffer_load_dword v255, v5, s[60:63], s9 offen
    s_mov_b64 exec, -1
    s_and_b32 s48, s4, 6
    s_add_u32 s49, s48, 1
    v_lshrrev_b32 v20, 3, v1
    v_lshrrev_b32 v21, 1, v20
    s_lshl_b32 s9, s8, 2
    v_xor_b32 v21, s9, v21
    v_and_b32 v22, 7, v1
    v_xor_b32 v21, v21, v22
    s_lshl_b32 s9, s8, 3
    v_add_u32 v26, s9, v20
    v_mul_u32_u24 v26, 1152, v26
    v_lshl_add_u32 v26, v21, 4, v26
    s_mul_i32 s9, s7, 18432
    v_add_u32 v24, s9, v26
    s_lshl_b32 s9, s7, 5
    v_xor_b32 v25, s9, v26
    s_mul_i32 s9, s7, 4608
    s_add_u32 s9, s9, 73728
    v_add_u32 v25, s9, v25
    v_and_b32 v21, 2, v20
    v_xor_b32 v21, v21, v22
    v_lshlrev_b32 v26, 13, v20
    v_xor_b32 v27, 4, v21
    v_lshl_add_u32 v27, v27, 4, v26
    v_lshl_add_u32 v26, v21, 4, v26
    v_add_u32 v27, 0xfc00, v27
    v_add_u32 v236, 0x1f800, v26
    v_add_u32 v237, 0x1f800, v27
    s_lshl_b32 s57, s7, 11
    s_lshl_b32 s9, s8, 10
    s_add_u32 s57, s57, s9
    s_lshl_b32 s58, s7, 9
    s_add_u32 s58, s58, s9
    s_add_u32 s58, s58, 8192
    s_mul_i32 s9, s4, 92160
    s_lshl_b32 s11, s5, 9
    s_lshl_b32 s10, s6, 7
    s_add_u32 s11, s11, s10
    s_mov_b32 s18, 92160
    s_mov_b32 s19, 0x20000
    s_sub_u32 s22, 4718592, s11
    s_mov_b32 s23, 0x20000
    v_lshlrev_b32 v21, s7, v3
    v_xor_b32 v21, v21, v2
    s_cmp_eq_u32 s7, 0
    s_cselect_b32 s59, 4, 8
    s_cselect_b32 s10, 8, 0
    s_cselect_b32 s34, 12, 8
    v_lshlrev_b32 v22, 8, v3
    v_lshl_add_u32 v4, v21, 4, v22
    v_xor_b32 v23, s59, v21
    v_lshl_add_u32 v5, v23, 4, v22
    v_xor_b32 v23, s10, v21
    v_lshl_add_u32 v6, v23, 4, v22
    v_xor_b32 v23, s34, v21
    v_lshl_add_u32 v7, v23, 4, v22
    s_lshl_b32 s32, s8, 13
    s_lshl_b32 s10, s4, 4
    s_add_u32 s10, s10, s5
    s_lshl_b32 s10, s10, 18
    s_mov_b32 s14, 262144
    s_mov_b32 s15, 0x20000
    s_lshr_b32 s100, 170, s4
    s_and_b32 s100, s100, 1
    s_waitcnt lgkmcnt(0)
    s_cmp_eq_u32 s7, 0
    s_cselect_b32 s12, s12, s44
    s_cselect_b32 s13, s13, s45
    s_add_u32 s12, s12, s10
    s_addc_u32 s13, s13, 0
    s_and_b32 s13, s13, 0xffff
    s_add_u32 s16, s16, s9
    s_addc_u32 s17, s17, 0
    s_and_b32 s17, s17, 0xffff
    s_add_u32 s20, s20, s11
    s_addc_u32 s21, s21, 0
    s_and_b32 s21, s21, 0xffff

    s_lshl_b32 s10, s48, 7
    s_add_u32 m0, s57, 131072
    s_add_u32 s11, s10, 36864
    buffer_load_dwordx4 v24, s[16:19], s10 offen  lds
    s_add_u32 m0, s57, 135168
    s_nop 0
    buffer_load_dwordx4 v24, s[16:19], s11 offen  lds
    s_add_u32 m0, s58, 131072
    s_mov_b32 exec_hi, 0
    buffer_load_dwordx4 v25, s[16:19], s10 offen  lds
    s_mov_b32 exec_hi, -1
    s_lshl_b32 s59, s48, 19
    s_add_u32 m0, s33, 65536
    s_nop 0
    buffer_load_dwordx4 v26, s[20:23], s59 offen offset:0  lds
    buffer_load_dwordx4 v27, s[20:23], s59 offen offset:1024  lds
    buffer_load_dwordx4 v236, s[20:23], s59 offen offset:2048  lds
    buffer_load_dwordx4 v237, s[20:23], s59 offen offset:3072  lds
    s_lshl_b32 s59, s48, 19
    s_add_u32 s59, s59, 262144
    s_add_u32 m0, s33, 69632
    s_nop 0
    buffer_load_dwordx4 v26, s[20:23], s59 offen offset:0  lds
    buffer_load_dwordx4 v27, s[20:23], s59 offen offset:1024  lds
    buffer_load_dwordx4 v236, s[20:23], s59 offen offset:2048  lds
    buffer_load_dwordx4 v237, s[20:23], s59 offen offset:3072  lds
    s_and_b32 s9, s5, 3
    s_mul_i32 s9, s9, 180
    s_mul_i32 s10, s6, 45
    s_add_u32 s9, s9, s10
    v_min_u32 v21, 44, v1
    v_add_lshl_u32 v21, v21, s9, 7
    buffer_load_dword v254, v21, s[16:19], 0 offen

    s_lshl_b32 s10, s49, 7
    s_add_u32 m0, s57, 141312
    s_add_u32 s11, s10, 36864
    buffer_load_dwordx4 v24, s[16:19], s10 offen  lds
    s_add_u32 m0, s57, 145408
    s_nop 0
    buffer_load_dwordx4 v24, s[16:19], s11 offen  lds
    s_add_u32 m0, s58, 141312
    s_mov_b32 exec_hi, 0
    buffer_load_dwordx4 v25, s[16:19], s10 offen  lds
    s_mov_b32 exec_hi, -1
    s_add_u32 s50, s49, 1
    s_cmp_eq_u32 s50, 9
    s_cselect_b32 s50, 0, s50
    s_add_u32 s51, s50, 1
    s_cmp_eq_u32 s51, 9
    s_cselect_b32 s51, 0, s51
    s_add_u32 s52, s51, 1
    s_cmp_eq_u32 s52, 9
    s_cselect_b32 s52, 0, s52
    s_add_u32 s53, s52, 1
    s_cmp_eq_u32 s53, 9
    s_cselect_b32 s53, 0, s53
    s_add_u32 s54, s53, 1
    s_cmp_eq_u32 s54, 9
    s_cselect_b32 s54, 0, s54
    s_add_u32 s55, s54, 1
    s_cmp_eq_u32 s55, 9
    s_cselect_b32 s55, 0, s55
    s_add_u32 s56, s55, 1
    s_cmp_eq_u32 s56, 9
    s_cselect_b32 s56, 0, s56
    v_lshrrev_b32 v21, 1, v2
    v_xor_b32 v21, v21, v3
    v_lshlrev_b32 v22, 7, v2
    v_lshl_add_u32 v28, v21, 4, v22
    v_xor_b32 v21, 4, v21
    v_lshl_add_u32 v29, v21, 4, v22
    v_add_u32 v30, 0x18000, v28
    v_add_u32 v31, 0x18000, v29

    v_lshrrev_b32 v21, 2, v2
    v_lshlrev_b32 v22, 7, v21
    v_lshl_add_u32 v22, v3, 10, v22
    v_and_b32 v23, 3, v2
    v_lshl_add_u32 v22, v23, 3, v22
    s_add_u32 s9, s33, 0x8000
    v_add_u32 v22, s9, v22
    v_lshrrev_b32 v21, 1, v21
    v_and_b32 v23, 1, v3
    v_lshl_or_b32 v21, v23, 1, v21

    v_xor_b32 v23, 0, v21
    v_lshl_add_u32 v200, v23, 5, v22
    v_xor_b32 v23, 1, v21
    v_lshl_add_u32 v201, v23, 5, v22
    v_xor_b32 v23, 2, v21
    v_lshl_add_u32 v202, v23, 5, v22
    v_xor_b32 v23, 3, v21
    v_lshl_add_u32 v203, v23, 5, v22
    s_mul_i32 s9, s5, 294912
    s_add_u32 s24, s24, s9
    s_addc_u32 s25, s25, 0
    s_and_b32 s25, s25, 0xffff
    s_mov_b32 s26, 294912
    s_mov_b32 s27, 0x20000
    s_mov_b32 s46, s28
    s_and_b32 s47, s29, 0xffff
    s_lshl_b32 s9, s3, 3
    s_add_u32 s39, s9, s4
    s_mul_i32 s9, s39, 1474560
    s_add_u32 s28, s28, s9
    s_addc_u32 s29, s29, 0
    s_and_b32 s29, s29, 0xffff
    s_mov_b32 s30, 1474560
    s_mov_b32 s31, 0x20000
    s_mul_i32 s42, s5, 92160
    s_mov_b32 s38, 0x40004000
    s_mov_b32 s40, 0x3e0293ee
    s_mov_b32 s41, 0x3e0293ee

    s_lshl_b32 s9, s39, 11
    s_add_u32 s9, s9, 25165824
    s_add_u32 s96, s46, s9
    s_addc_u32 s97, s47, 0
    s_mov_b32 s98, 2048
    s_mov_b32 s99, 0x20000
    s_and_b32 s101, s5, 3
    s_lshl_b32 s101, s101, 2
    s_lshr_b32 s9, s5, 2
    s_add_u32 s101, s101, s9
    s_lshl_b32 s9, s101, 7
    v_mov_b32 v21, 0
    s_mov_b64 exec, 1
    buffer_store_dword v21, v21, s[96:99], s9 offen sc1
    s_mov_b64 exec, -1

    v_xor_b32 v21, v3, v2
    s_lshl_b32 s9, s8, 13
    s_add_u32 s9, s9, 131072
    v_lshlrev_b32 v22, 8, v2
    v_add_u32 v22, s9, v22

    v_xor_b32 v23, 0, v21
    v_lshl_add_u32 v8, v23, 4, v22
    v_xor_b32 v23, 4, v21
    v_lshl_add_u32 v9, v23, 4, v22
    v_xor_b32 v23, 8, v21
    v_lshl_add_u32 v10, v23, 4, v22
    v_xor_b32 v23, 12, v21
    v_lshl_add_u32 v11, v23, 4, v22
    v_lshrrev_b32 v21, 2, v2
    v_lshl_add_u32 v22, v3, 2, v21
    v_and_b32 v21, 7, v22
    v_lshlrev_b32 v22, 8, v22
    v_and_b32 v23, 3, v2
    v_lshl_add_u32 v22, v23, 3, v22
    s_add_u32 s9, s9, 16384
    v_add_u32 v22, s9, v22
    s_lshl_b32 s10, s8, 2
    v_xor_b32 v21, s10, v21

    v_xor_b32 v23, 0, v21
    v_lshl_add_u32 v12, v23, 5, v22
    v_xor_b32 v23, 1, v21
    v_lshl_add_u32 v13, v23, 5, v22
    v_xor_b32 v23, 2, v21
    v_lshl_add_u32 v14, v23, 5, v22
    v_xor_b32 v23, 3, v21
    v_lshl_add_u32 v15, v23, 5, v22
    v_xor_b32 v23, 4, v21
    v_lshl_add_u32 v16, v23, 5, v22
    v_xor_b32 v23, 5, v21
    v_lshl_add_u32 v17, v23, 5, v22
    v_xor_b32 v23, 6, v21
    v_lshl_add_u32 v18, v23, 5, v22
    v_xor_b32 v23, 7, v21
    v_lshl_add_u32 v19, v23, 5, v22
    s_mov_b32 s9, 0x3f803f80
    v_accvgpr_write_b32 a244, s9
    v_accvgpr_write_b32 a245, s9
    v_accvgpr_write_b32 a246, s9
    v_accvgpr_write_b32 a247, s9
    v_lshrrev_b32 v21, 3, v1
    v_mul_u32_u24 v23, 1152, v21
    v_and_b32 v21, 6, v21
    v_and_b32 v22, 7, v1
    v_xor_b32 v21, v21, v22
    v_lshl_add_u32 v23, v21, 4, v23
    s_mul_i32 s35, s6, 73728
    s_xor_b32 s11, s6, 1
    v_lshlrev_b32 v20, 4, v1
    v_lshlrev_b32 v22, 2, v1
    s_mul_i32 s9, s11, 10240
    s_add_u32 s9, s9, 122880
    v_add_u32 v192, s9, v20
    s_mul_i32 s9, s6, 10240
    s_add_u32 s9, s9, 122880
    v_add_u32 v193, s9, v20
    s_mul_i32 s9, s11, 12800
    s_add_u32 s9, s9, 65536
    v_add_u32 v194, s9, v20
    v_add_u32 v196, s9, v22
    s_mul_i32 s9, s6, 12800
    s_add_u32 s9, s9, 65536
    v_add_u32 v195, s9, v20
    v_add_u32 v197, s9, v22
    v_lshrrev_b32 v21, 1, v3
    v_lshl_add_u32 v21, v21, 4, v2
    v_lshlrev_b32 v21, 4, v21
    v_and_b32 v22, 1, v3
    v_lshl_add_u32 v21, v22, 3, v21
    s_lshl_b32 s9, s7, 14
    s_lshl_b32 s10, s8, 11
    s_add_u32 s10, s10, s9
    s_add_u32 s10, s10, 98304
    v_add_u32 v198, s10, v21
    s_add_u32 s10, s33, 65536
    v_add_u32 v244, s10, v21
    s_add_u32 s9, s9, 65536
    v_add_u32 v199, s9, v20
    s_mov_b32 s34, 0
    s_mov_b32 s44, 0
    s_mov_b32 s36, -131072

    s_lshl_b32 s59, s49, 19
    s_add_u32 m0, s33, 32768
    s_nop 0
    buffer_load_dwordx4 v26, s[20:23], s59 offen offset:0  lds
    buffer_load_dwordx4 v27, s[20:23], s59 offen offset:1024  lds
    buffer_load_dwordx4 v236, s[20:23], s59 offen offset:2048  lds
    buffer_load_dwordx4 v237, s[20:23], s59 offen offset:3072  lds
    s_lshl_b32 s59, s49, 19
    s_add_u32 s59, s59, 262144
    s_add_u32 m0, s33, 36864
    s_nop 0
    buffer_load_dwordx4 v26, s[20:23], s59 offen offset:0  lds
    buffer_load_dwordx4 v27, s[20:23], s59 offen offset:1024  lds
    buffer_load_dwordx4 v236, s[20:23], s59 offen offset:2048  lds
    buffer_load_dwordx4 v237, s[20:23], s59 offen offset:3072  lds
    v_accvgpr_write_b32 a0, 0
    v_accvgpr_write_b32 a1, 0
    v_accvgpr_write_b32 a2, 0
    v_accvgpr_write_b32 a3, 0
    v_accvgpr_write_b32 a4, 0
    v_accvgpr_write_b32 a5, 0
    v_accvgpr_write_b32 a6, 0
    v_accvgpr_write_b32 a7, 0
    v_accvgpr_write_b32 a8, 0
    v_accvgpr_write_b32 a9, 0
    v_accvgpr_write_b32 a10, 0
    v_accvgpr_write_b32 a11, 0
    v_accvgpr_write_b32 a12, 0
    v_accvgpr_write_b32 a13, 0
    v_accvgpr_write_b32 a14, 0
    v_accvgpr_write_b32 a15, 0
    v_accvgpr_write_b32 a16, 0
    v_accvgpr_write_b32 a17, 0
    v_accvgpr_write_b32 a18, 0
    v_accvgpr_write_b32 a19, 0
    v_accvgpr_write_b32 a20, 0
    v_accvgpr_write_b32 a21, 0
    v_accvgpr_write_b32 a22, 0
    v_accvgpr_write_b32 a23, 0
    v_accvgpr_write_b32 a24, 0
    v_accvgpr_write_b32 a25, 0
    v_accvgpr_write_b32 a26, 0
    v_accvgpr_write_b32 a27, 0
    v_accvgpr_write_b32 a28, 0
    v_accvgpr_write_b32 a29, 0
    v_accvgpr_write_b32 a30, 0
    v_accvgpr_write_b32 a31, 0
    v_accvgpr_write_b32 a32, 0
    v_accvgpr_write_b32 a33, 0
    v_accvgpr_write_b32 a34, 0
    v_accvgpr_write_b32 a35, 0
    v_accvgpr_write_b32 a36, 0
    v_accvgpr_write_b32 a37, 0
    v_accvgpr_write_b32 a38, 0
    v_accvgpr_write_b32 a39, 0
    v_accvgpr_write_b32 a40, 0
    v_accvgpr_write_b32 a41, 0
    v_accvgpr_write_b32 a42, 0
    v_accvgpr_write_b32 a43, 0
    v_accvgpr_write_b32 a44, 0
    v_accvgpr_write_b32 a45, 0
    v_accvgpr_write_b32 a46, 0
    v_accvgpr_write_b32 a47, 0
    v_accvgpr_write_b32 a48, 0
    v_accvgpr_write_b32 a49, 0
    v_accvgpr_write_b32 a50, 0
    v_accvgpr_write_b32 a51, 0
    v_accvgpr_write_b32 a52, 0
    v_accvgpr_write_b32 a53, 0
    v_accvgpr_write_b32 a54, 0
    v_accvgpr_write_b32 a55, 0
    v_accvgpr_write_b32 a56, 0
    v_accvgpr_write_b32 a57, 0
    v_accvgpr_write_b32 a58, 0
    v_accvgpr_write_b32 a59, 0
    v_accvgpr_write_b32 a60, 0
    v_accvgpr_write_b32 a61, 0
    v_accvgpr_write_b32 a62, 0
    v_accvgpr_write_b32 a63, 0
    v_accvgpr_write_b32 a64, 0
    v_accvgpr_write_b32 a65, 0
    v_accvgpr_write_b32 a66, 0
    v_accvgpr_write_b32 a67, 0
    v_accvgpr_write_b32 a68, 0
    v_accvgpr_write_b32 a69, 0
    v_accvgpr_write_b32 a70, 0
    v_accvgpr_write_b32 a71, 0
    v_accvgpr_write_b32 a72, 0
    v_accvgpr_write_b32 a73, 0
    v_accvgpr_write_b32 a74, 0
    v_accvgpr_write_b32 a75, 0
    v_accvgpr_write_b32 a76, 0
    v_accvgpr_write_b32 a77, 0
    v_accvgpr_write_b32 a78, 0
    v_accvgpr_write_b32 a79, 0
    v_accvgpr_write_b32 a80, 0
    v_accvgpr_write_b32 a81, 0
    v_accvgpr_write_b32 a82, 0
    v_accvgpr_write_b32 a83, 0
    v_accvgpr_write_b32 a84, 0
    v_accvgpr_write_b32 a85, 0
    v_accvgpr_write_b32 a86, 0
    v_accvgpr_write_b32 a87, 0
    v_accvgpr_write_b32 a88, 0
    v_accvgpr_write_b32 a89, 0
    v_accvgpr_write_b32 a90, 0
    v_accvgpr_write_b32 a91, 0
    v_accvgpr_write_b32 a92, 0
    v_accvgpr_write_b32 a93, 0
    v_accvgpr_write_b32 a94, 0
    v_accvgpr_write_b32 a95, 0
    v_accvgpr_write_b32 a96, 0
    v_accvgpr_write_b32 a97, 0
    v_accvgpr_write_b32 a98, 0
    v_accvgpr_write_b32 a99, 0
    v_mov_b64 v[112:113], 0
    v_mov_b64 v[114:115], 0
    v_mov_b64 v[116:117], 0
    v_mov_b64 v[118:119], 0
    v_mov_b64 v[120:121], 0
    v_mov_b64 v[122:123], 0
    v_mov_b64 v[124:125], 0
    v_mov_b64 v[126:127], 0
    v_mov_b64 v[128:129], 0
    v_mov_b64 v[130:131], 0
    v_mov_b64 v[132:133], 0
    v_mov_b64 v[134:135], 0
    v_mov_b64 v[136:137], 0
    v_mov_b64 v[138:139], 0
    v_mov_b64 v[140:141], 0
    v_mov_b64 v[142:143], 0
    v_mov_b64 v[144:145], 0
    v_mov_b64 v[146:147], 0
    v_mov_b64 v[148:149], 0
    v_mov_b64 v[150:151], 0
    v_mov_b64 v[152:153], 0
    v_mov_b64 v[154:155], 0
    v_mov_b64 v[156:157], 0
    v_mov_b64 v[158:159], 0
    v_mov_b64 v[160:161], 0
    v_mov_b64 v[162:163], 0
    v_mov_b64 v[164:165], 0
    v_mov_b64 v[166:167], 0
    v_mov_b64 v[168:169], 0
    v_mov_b64 v[170:171], 0
    v_mov_b64 v[172:173], 0
    v_mov_b64 v[174:175], 0
    v_mov_b64 v[176:177], 0
    v_mov_b64 v[178:179], 0
    v_mov_b64 v[180:181], 0
    v_mov_b64 v[182:183], 0
    v_mov_b64 v[184:185], 0
    v_mov_b64 v[186:187], 0
    v_mov_b64 v[188:189], 0
    v_mov_b64 v[190:191], 0
    v_mov_b64 v[246:247], v[4:5]
    v_mov_b64 v[248:249], v[6:7]
    s_waitcnt vmcnt(17)
    s_barrier
    ds_read_b64_tr_b16 a[140:141], v200 offset:32768
    ds_read_b64_tr_b16 a[142:143], v200 offset:33280
    ds_read_b64_tr_b16 a[144:145], v201 offset:32768
    ds_read_b64_tr_b16 a[146:147], v201 offset:33280
    ds_read_b64_tr_b16 a[148:149], v202 offset:32768
    ds_read_b64_tr_b16 a[150:151], v202 offset:33280
    ds_read_b64_tr_b16 a[152:153], v203 offset:32768
    ds_read_b64_tr_b16 a[154:155], v203 offset:33280
    ds_read_b128 a[100:103], v30 offset:32768
    ds_read_b128 a[104:107], v30 offset:34816
    ds_read_b128 a[108:111], v30 offset:36864
    ds_read_b128 a[112:115], v30 offset:38912
    ds_read_b128 a[116:119], v30 offset:40960
    s_lshl_b32 s59, s50, 19
    s_add_u32 m0, s33, 65536
    s_waitcnt lgkmcnt(4)
    v_mfma_f32_16x16x32_bf16 v[32:35], a[140:143], a[100:103], 0
    buffer_load_dwordx4 v26, s[20:23], s59 offen offset:0  lds
    v_mfma_f32_16x16x32_bf16 v[52:55], a[144:147], a[100:103], 0
    buffer_load_dwordx4 v27, s[20:23], s59 offen offset:1024  lds
    v_mfma_f32_16x16x32_bf16 v[72:75], a[148:151], a[100:103], 0
    buffer_load_dwordx4 v236, s[20:23], s59 offen offset:2048  lds
    v_mfma_f32_16x16x32_bf16 v[92:95], a[152:155], a[100:103], 0
    buffer_load_dwordx4 v237, s[20:23], s59 offen offset:3072  lds
    s_waitcnt vmcnt(17)
    s_waitcnt lgkmcnt(0)
    v_mfma_f32_16x16x32_bf16 v[36:39], a[140:143], a[104:107], 0
    ds_read_b64_tr_b16 a[156:157], v200 offset:36864
    v_mfma_f32_16x16x32_bf16 v[56:59], a[144:147], a[104:107], 0
    ds_read_b64_tr_b16 a[158:159], v200 offset:37376
    v_mfma_f32_16x16x32_bf16 v[76:79], a[148:151], a[104:107], 0
    ds_read_b64_tr_b16 a[160:161], v201 offset:36864
    v_mfma_f32_16x16x32_bf16 v[96:99], a[152:155], a[104:107], 0
    ds_read_b64_tr_b16 a[162:163], v201 offset:37376
    v_mfma_f32_16x16x32_bf16 v[40:43], a[140:143], a[108:111], 0
    ds_read_b64_tr_b16 a[164:165], v202 offset:36864
    v_mfma_f32_16x16x32_bf16 v[60:63], a[144:147], a[108:111], 0
    ds_read_b64_tr_b16 a[166:167], v202 offset:37376
    v_mfma_f32_16x16x32_bf16 v[80:83], a[148:151], a[108:111], 0
    ds_read_b64_tr_b16 a[168:169], v203 offset:36864
    v_mfma_f32_16x16x32_bf16 v[100:103], a[152:155], a[108:111], 0
    ds_read_b64_tr_b16 a[170:171], v203 offset:37376
    v_mfma_f32_16x16x32_bf16 v[44:47], a[140:143], a[112:115], 0
    ds_read_b128 a[120:123], v31 offset:32768
    v_mfma_f32_16x16x32_bf16 v[64:67], a[144:147], a[112:115], 0
    ds_read_b128 a[124:127], v31 offset:34816
    v_mfma_f32_16x16x32_bf16 v[84:87], a[148:151], a[112:115], 0
    ds_read_b128 a[128:131], v31 offset:36864
    v_mfma_f32_16x16x32_bf16 v[104:107], a[152:155], a[112:115], 0
    ds_read_b128 a[132:135], v31 offset:38912
    v_mfma_f32_16x16x32_bf16 v[48:51], a[140:143], a[116:119], 0
    ds_read_b128 a[136:139], v31 offset:40960
    v_mfma_f32_16x16x32_bf16 v[68:71], a[144:147], a[116:119], 0
    s_lshl_b32 s10, s50, 7
    s_add_u32 m0, s57, 151552
    s_add_u32 s11, s10, 36864
    buffer_load_dwordx4 v24, s[16:19], s10 offen  lds
    v_mfma_f32_16x16x32_bf16 v[88:91], a[148:151], a[116:119], 0
    s_add_u32 m0, s57, 155648
    s_nop 0
    buffer_load_dwordx4 v24, s[16:19], s11 offen  lds
    v_mfma_f32_16x16x32_bf16 v[108:111], a[152:155], a[116:119], 0
    s_add_u32 m0, s58, 151552
    s_mov_b32 exec_hi, 0
    buffer_load_dwordx4 v25, s[16:19], s10 offen  lds
    s_mov_b32 exec_hi, -1
    s_lshl_b32 s59, s50, 19
    s_add_u32 s59, s59, 262144
    s_add_u32 m0, s33, 69632
    s_waitcnt lgkmcnt(4)
    v_mfma_f32_16x16x32_bf16 v[32:35], a[156:159], a[120:123], v[32:35]
    buffer_load_dwordx4 v26, s[20:23], s59 offen offset:0  lds
    v_mfma_f32_16x16x32_bf16 v[52:55], a[160:163], a[120:123], v[52:55]
    buffer_load_dwordx4 v27, s[20:23], s59 offen offset:1024  lds
    v_mfma_f32_16x16x32_bf16 v[72:75], a[164:167], a[120:123], v[72:75]
    buffer_load_dwordx4 v236, s[20:23], s59 offen offset:2048  lds
    v_mfma_f32_16x16x32_bf16 v[92:95], a[168:171], a[120:123], v[92:95]
    buffer_load_dwordx4 v237, s[20:23], s59 offen offset:3072  lds
    s_waitcnt vmcnt(15)
    s_waitcnt lgkmcnt(0)
    s_barrier
    v_mfma_f32_16x16x32_bf16 v[36:39], a[156:159], a[124:127], v[36:39]
    ds_read_b64_tr_b16 a[140:141], v200 offset:0
    v_mfma_f32_16x16x32_bf16 v[56:59], a[160:163], a[124:127], v[56:59]
    ds_read_b64_tr_b16 a[142:143], v200 offset:512
    v_mfma_f32_16x16x32_bf16 v[76:79], a[164:167], a[124:127], v[76:79]
    ds_read_b64_tr_b16 a[144:145], v201 offset:0
    v_mfma_f32_16x16x32_bf16 v[96:99], a[168:171], a[124:127], v[96:99]
    ds_read_b64_tr_b16 a[146:147], v201 offset:512
    v_mfma_f32_16x16x32_bf16 v[40:43], a[156:159], a[128:131], v[40:43]
    ds_read_b64_tr_b16 a[148:149], v202 offset:0
    v_mfma_f32_16x16x32_bf16 v[60:63], a[160:163], a[128:131], v[60:63]
    ds_read_b64_tr_b16 a[150:151], v202 offset:512
    v_mfma_f32_16x16x32_bf16 v[80:83], a[164:167], a[128:131], v[80:83]
    ds_read_b64_tr_b16 a[152:153], v203 offset:0
    v_mfma_f32_16x16x32_bf16 v[100:103], a[168:171], a[128:131], v[100:103]
    ds_read_b64_tr_b16 a[154:155], v203 offset:512
    v_mfma_f32_16x16x32_bf16 v[44:47], a[156:159], a[132:135], v[44:47]
    ds_read_b128 a[100:103], v30 offset:43008
    v_mfma_f32_16x16x32_bf16 v[64:67], a[160:163], a[132:135], v[64:67]
    ds_read_b128 a[104:107], v30 offset:45056
    v_mfma_f32_16x16x32_bf16 v[84:87], a[164:167], a[132:135], v[84:87]
    ds_read_b128 a[108:111], v30 offset:47104
    v_mfma_f32_16x16x32_bf16 v[104:107], a[168:171], a[132:135], v[104:107]
    ds_read_b128 a[112:115], v30 offset:49152
    v_mfma_f32_16x16x32_bf16 v[48:51], a[156:159], a[136:139], v[48:51]
    ds_read_b128 a[116:119], v30 offset:51200
    v_mfma_f32_16x16x32_bf16 v[68:71], a[160:163], a[136:139], v[68:71]
    s_lshl_b32 s10, s51, 7
    s_add_u32 m0, s57, 0
    s_add_u32 s11, s10, 36864
    buffer_load_dwordx4 v24, s[16:19], s10 offen  lds
    v_mfma_f32_16x16x32_bf16 v[88:91], a[164:167], a[136:139], v[88:91]
    s_add_u32 m0, s57, 4096
    s_nop 0
    buffer_load_dwordx4 v24, s[16:19], s11 offen  lds
    v_mfma_f32_16x16x32_bf16 v[108:111], a[168:171], a[136:139], v[108:111]
    s_add_u32 m0, s58, 0
    s_mov_b32 exec_hi, 0
    buffer_load_dwordx4 v25, s[16:19], s10 offen  lds
    s_mov_b32 exec_hi, -1
    s_lshl_b32 s59, s51, 19
    s_add_u32 m0, s33, 32768
    s_waitcnt lgkmcnt(4)
    v_mfma_f32_16x16x32_bf16 v[32:35], a[140:143], a[100:103], v[32:35]
    buffer_load_dwordx4 v26, s[20:23], s59 offen offset:0  lds
    v_mfma_f32_16x16x32_bf16 v[52:55], a[144:147], a[100:103], v[52:55]
    buffer_load_dwordx4 v27, s[20:23], s59 offen offset:1024  lds
    v_mfma_f32_16x16x32_bf16 v[72:75], a[148:151], a[100:103], v[72:75]
    buffer_load_dwordx4 v236, s[20:23], s59 offen offset:2048  lds
    v_mfma_f32_16x16x32_bf16 v[92:95], a[152:155], a[100:103], v[92:95]
    buffer_load_dwordx4 v237, s[20:23], s59 offen offset:3072  lds
    s_waitcnt vmcnt(18)
    s_waitcnt lgkmcnt(0)
    v_mfma_f32_16x16x32_bf16 v[36:39], a[140:143], a[104:107], v[36:39]
    ds_read_b64_tr_b16 a[156:157], v200 offset:4096
    v_mfma_f32_16x16x32_bf16 v[56:59], a[144:147], a[104:107], v[56:59]
    ds_read_b64_tr_b16 a[158:159], v200 offset:4608
    v_mfma_f32_16x16x32_bf16 v[76:79], a[148:151], a[104:107], v[76:79]
    ds_read_b64_tr_b16 a[160:161], v201 offset:4096
    v_mfma_f32_16x16x32_bf16 v[96:99], a[152:155], a[104:107], v[96:99]
    ds_read_b64_tr_b16 a[162:163], v201 offset:4608
    v_mfma_f32_16x16x32_bf16 v[40:43], a[140:143], a[108:111], v[40:43]
    ds_read_b64_tr_b16 a[164:165], v202 offset:4096
    v_mfma_f32_16x16x32_bf16 v[60:63], a[144:147], a[108:111], v[60:63]
    ds_read_b64_tr_b16 a[166:167], v202 offset:4608
    v_mfma_f32_16x16x32_bf16 v[80:83], a[148:151], a[108:111], v[80:83]
    ds_read_b64_tr_b16 a[168:169], v203 offset:4096
    v_mfma_f32_16x16x32_bf16 v[100:103], a[152:155], a[108:111], v[100:103]
    ds_read_b64_tr_b16 a[170:171], v203 offset:4608
    v_mfma_f32_16x16x32_bf16 v[44:47], a[140:143], a[112:115], v[44:47]
    ds_read_b128 a[120:123], v31 offset:43008
    v_mfma_f32_16x16x32_bf16 v[64:67], a[144:147], a[112:115], v[64:67]
    ds_read_b128 a[124:127], v31 offset:45056
    v_mfma_f32_16x16x32_bf16 v[84:87], a[148:151], a[112:115], v[84:87]
    ds_read_b128 a[128:131], v31 offset:47104
    v_mfma_f32_16x16x32_bf16 v[104:107], a[152:155], a[112:115], v[104:107]
    ds_read_b128 a[132:135], v31 offset:49152
    v_mfma_f32_16x16x32_bf16 v[48:51], a[140:143], a[116:119], v[48:51]
    ds_read_b128 a[136:139], v31 offset:51200
    v_mfma_f32_16x16x32_bf16 v[68:71], a[144:147], a[116:119], v[68:71]
    s_lshl_b32 s10, s52, 7
    s_add_u32 m0, s57, 10240
    s_add_u32 s11, s10, 36864
    buffer_load_dwordx4 v24, s[16:19], s10 offen  lds
    v_mfma_f32_16x16x32_bf16 v[88:91], a[148:151], a[116:119], v[88:91]
    s_add_u32 m0, s57, 14336
    s_nop 0
    buffer_load_dwordx4 v24, s[16:19], s11 offen  lds
    v_mfma_f32_16x16x32_bf16 v[108:111], a[152:155], a[116:119], v[108:111]
    s_add_u32 m0, s58, 10240
    s_mov_b32 exec_hi, 0
    buffer_load_dwordx4 v25, s[16:19], s10 offen  lds
    s_mov_b32 exec_hi, -1
    s_lshl_b32 s59, s51, 19
    s_add_u32 s59, s59, 262144
    s_add_u32 m0, s33, 36864
    s_waitcnt lgkmcnt(4)
    v_mfma_f32_16x16x32_bf16 v[32:35], a[156:159], a[120:123], v[32:35]
    buffer_load_dwordx4 v26, s[20:23], s59 offen offset:0  lds
    v_mfma_f32_16x16x32_bf16 v[52:55], a[160:163], a[120:123], v[52:55]
    buffer_load_dwordx4 v27, s[20:23], s59 offen offset:1024  lds
    v_mfma_f32_16x16x32_bf16 v[72:75], a[164:167], a[120:123], v[72:75]
    buffer_load_dwordx4 v236, s[20:23], s59 offen offset:2048  lds
    v_mfma_f32_16x16x32_bf16 v[92:95], a[168:171], a[120:123], v[92:95]
    buffer_load_dwordx4 v237, s[20:23], s59 offen offset:3072  lds
    s_waitcnt vmcnt(18)
    s_waitcnt lgkmcnt(0)
    s_barrier
    v_mfma_f32_16x16x32_bf16 v[36:39], a[156:159], a[124:127], v[36:39]
    ds_read_b64_tr_b16 a[140:141], v200 offset:32768
    v_mfma_f32_16x16x32_bf16 v[56:59], a[160:163], a[124:127], v[56:59]
    ds_read_b64_tr_b16 a[142:143], v200 offset:33280
    v_mfma_f32_16x16x32_bf16 v[76:79], a[164:167], a[124:127], v[76:79]
    ds_read_b64_tr_b16 a[144:145], v201 offset:32768
    v_mfma_f32_16x16x32_bf16 v[96:99], a[168:171], a[124:127], v[96:99]
    ds_read_b64_tr_b16 a[146:147], v201 offset:33280
    v_mfma_f32_16x16x32_bf16 v[40:43], a[156:159], a[128:131], v[40:43]
    ds_read_b64_tr_b16 a[148:149], v202 offset:32768
    v_mfma_f32_16x16x32_bf16 v[60:63], a[160:163], a[128:131], v[60:63]
    ds_read_b64_tr_b16 a[150:151], v202 offset:33280
    v_mfma_f32_16x16x32_bf16 v[80:83], a[164:167], a[128:131], v[80:83]
    ds_read_b64_tr_b16 a[152:153], v203 offset:32768
    v_mfma_f32_16x16x32_bf16 v[100:103], a[168:171], a[128:131], v[100:103]
    ds_read_b64_tr_b16 a[154:155], v203 offset:33280
    v_mfma_f32_16x16x32_bf16 v[44:47], a[156:159], a[132:135], v[44:47]
    ds_read_b128 a[100:103], v30 offset:53248
    v_mfma_f32_16x16x32_bf16 v[64:67], a[160:163], a[132:135], v[64:67]
    ds_read_b128 a[104:107], v30 offset:55296
    v_mfma_f32_16x16x32_bf16 v[84:87], a[164:167], a[132:135], v[84:87]
    ds_read_b128 a[108:111], v30 offset:57344
    v_mfma_f32_16x16x32_bf16 v[104:107], a[168:171], a[132:135], v[104:107]
    ds_read_b128 a[112:115], v30 offset:59392
    v_mfma_f32_16x16x32_bf16 v[48:51], a[156:159], a[136:139], v[48:51]
    ds_read_b128 a[116:119], v30 offset:61440
    v_mfma_f32_16x16x32_bf16 v[68:71], a[160:163], a[136:139], v[68:71]
    s_lshl_b32 s59, s52, 19
    v_mfma_f32_16x16x32_bf16 v[88:91], a[164:167], a[136:139], v[88:91]
    s_add_u32 m0, s33, 65536
    v_mfma_f32_16x16x32_bf16 v[108:111], a[168:171], a[136:139], v[108:111]
    s_waitcnt lgkmcnt(4)
    v_mfma_f32_16x16x32_bf16 v[32:35], a[140:143], a[100:103], v[32:35]
    buffer_load_dwordx4 v26, s[20:23], s59 offen offset:0  lds
    v_mfma_f32_16x16x32_bf16 v[52:55], a[144:147], a[100:103], v[52:55]
    buffer_load_dwordx4 v27, s[20:23], s59 offen offset:1024  lds
    v_mfma_f32_16x16x32_bf16 v[72:75], a[148:151], a[100:103], v[72:75]
    buffer_load_dwordx4 v236, s[20:23], s59 offen offset:2048  lds
    v_mfma_f32_16x16x32_bf16 v[92:95], a[152:155], a[100:103], v[92:95]
    buffer_load_dwordx4 v237, s[20:23], s59 offen offset:3072  lds
    s_waitcnt vmcnt(18)
    s_waitcnt lgkmcnt(0)
    v_mfma_f32_16x16x32_bf16 v[36:39], a[140:143], a[104:107], v[36:39]
    ds_read_b64_tr_b16 a[156:157], v200 offset:36864
    v_mfma_f32_16x16x32_bf16 v[56:59], a[144:147], a[104:107], v[56:59]
    ds_read_b64_tr_b16 a[158:159], v200 offset:37376
    v_mfma_f32_16x16x32_bf16 v[76:79], a[148:151], a[104:107], v[76:79]
    ds_read_b64_tr_b16 a[160:161], v201 offset:36864
    v_mfma_f32_16x16x32_bf16 v[96:99], a[152:155], a[104:107], v[96:99]
    ds_read_b64_tr_b16 a[162:163], v201 offset:37376
    v_mfma_f32_16x16x32_bf16 v[40:43], a[140:143], a[108:111], v[40:43]
    ds_read_b64_tr_b16 a[164:165], v202 offset:36864
    v_mfma_f32_16x16x32_bf16 v[60:63], a[144:147], a[108:111], v[60:63]
    ds_read_b64_tr_b16 a[166:167], v202 offset:37376
    v_mfma_f32_16x16x32_bf16 v[80:83], a[148:151], a[108:111], v[80:83]
    ds_read_b64_tr_b16 a[168:169], v203 offset:36864
    v_mfma_f32_16x16x32_bf16 v[100:103], a[152:155], a[108:111], v[100:103]
    ds_read_b64_tr_b16 a[170:171], v203 offset:37376
    v_mfma_f32_16x16x32_bf16 v[44:47], a[140:143], a[112:115], v[44:47]
    ds_read_b128 a[120:123], v31 offset:53248
    v_mfma_f32_16x16x32_bf16 v[64:67], a[144:147], a[112:115], v[64:67]
    ds_read_b128 a[124:127], v31 offset:55296
    v_mfma_f32_16x16x32_bf16 v[84:87], a[148:151], a[112:115], v[84:87]
    ds_read_b128 a[128:131], v31 offset:57344
    v_mfma_f32_16x16x32_bf16 v[104:107], a[152:155], a[112:115], v[104:107]
    ds_read_b128 a[132:135], v31 offset:59392
    v_mfma_f32_16x16x32_bf16 v[48:51], a[140:143], a[116:119], v[48:51]
    ds_read_b128 a[136:139], v31 offset:61440
    v_mfma_f32_16x16x32_bf16 v[68:71], a[144:147], a[116:119], v[68:71]
    s_lshl_b32 s10, s53, 7
    s_add_u32 m0, s57, 20480
    s_add_u32 s11, s10, 36864
    buffer_load_dwordx4 v24, s[16:19], s10 offen  lds
    v_mfma_f32_16x16x32_bf16 v[88:91], a[148:151], a[116:119], v[88:91]
    s_add_u32 m0, s57, 24576
    s_nop 0
    buffer_load_dwordx4 v24, s[16:19], s11 offen  lds
    v_mfma_f32_16x16x32_bf16 v[108:111], a[152:155], a[116:119], v[108:111]
    s_add_u32 m0, s58, 20480
    s_mov_b32 exec_hi, 0
    buffer_load_dwordx4 v25, s[16:19], s10 offen  lds
    s_mov_b32 exec_hi, -1
    s_lshl_b32 s59, s52, 19
    s_add_u32 s59, s59, 262144
    s_add_u32 m0, s33, 69632
    s_waitcnt lgkmcnt(4)
    v_mfma_f32_16x16x32_bf16 v[32:35], a[156:159], a[120:123], v[32:35]
    buffer_load_dwordx4 v26, s[20:23], s59 offen offset:0  lds
    v_mfma_f32_16x16x32_bf16 v[52:55], a[160:163], a[120:123], v[52:55]
    buffer_load_dwordx4 v27, s[20:23], s59 offen offset:1024  lds
    v_mfma_f32_16x16x32_bf16 v[72:75], a[164:167], a[120:123], v[72:75]
    buffer_load_dwordx4 v236, s[20:23], s59 offen offset:2048  lds
    v_mfma_f32_16x16x32_bf16 v[92:95], a[168:171], a[120:123], v[92:95]
    buffer_load_dwordx4 v237, s[20:23], s59 offen offset:3072  lds
    s_waitcnt vmcnt(15)
    s_waitcnt lgkmcnt(0)
    s_barrier
    v_mfma_f32_16x16x32_bf16 v[36:39], a[156:159], a[124:127], v[36:39]
    ds_read_b64_tr_b16 a[140:141], v200 offset:0
    v_mfma_f32_16x16x32_bf16 v[56:59], a[160:163], a[124:127], v[56:59]
    ds_read_b64_tr_b16 a[142:143], v200 offset:512
    v_mfma_f32_16x16x32_bf16 v[76:79], a[164:167], a[124:127], v[76:79]
    ds_read_b64_tr_b16 a[144:145], v201 offset:0
    v_mfma_f32_16x16x32_bf16 v[96:99], a[168:171], a[124:127], v[96:99]
    ds_read_b64_tr_b16 a[146:147], v201 offset:512
    v_mfma_f32_16x16x32_bf16 v[40:43], a[156:159], a[128:131], v[40:43]
    ds_read_b64_tr_b16 a[148:149], v202 offset:0
    v_mfma_f32_16x16x32_bf16 v[60:63], a[160:163], a[128:131], v[60:63]
    ds_read_b64_tr_b16 a[150:151], v202 offset:512
    v_mfma_f32_16x16x32_bf16 v[80:83], a[164:167], a[128:131], v[80:83]
    ds_read_b64_tr_b16 a[152:153], v203 offset:0
    v_mfma_f32_16x16x32_bf16 v[100:103], a[168:171], a[128:131], v[100:103]
    ds_read_b64_tr_b16 a[154:155], v203 offset:512
    v_mfma_f32_16x16x32_bf16 v[44:47], a[156:159], a[132:135], v[44:47]
    ds_read_b128 a[100:103], v28 offset:0
    v_mfma_f32_16x16x32_bf16 v[64:67], a[160:163], a[132:135], v[64:67]
    ds_read_b128 a[104:107], v28 offset:2048
    v_mfma_f32_16x16x32_bf16 v[84:87], a[164:167], a[132:135], v[84:87]
    ds_read_b128 a[108:111], v28 offset:4096
    v_mfma_f32_16x16x32_bf16 v[104:107], a[168:171], a[132:135], v[104:107]
    ds_read_b128 a[112:115], v28 offset:6144
    v_mfma_f32_16x16x32_bf16 v[48:51], a[156:159], a[136:139], v[48:51]
    ds_read_b128 a[116:119], v28 offset:8192
    v_mfma_f32_16x16x32_bf16 v[68:71], a[160:163], a[136:139], v[68:71]
    s_lshl_b32 s59, s53, 19
    v_mfma_f32_16x16x32_bf16 v[88:91], a[164:167], a[136:139], v[88:91]
    s_add_u32 m0, s33, 32768
    v_mfma_f32_16x16x32_bf16 v[108:111], a[168:171], a[136:139], v[108:111]
    s_waitcnt lgkmcnt(4)
    v_mfma_f32_16x16x32_bf16 v[32:35], a[140:143], a[100:103], v[32:35]
    buffer_load_dwordx4 v26, s[20:23], s59 offen offset:0  lds
    v_mfma_f32_16x16x32_bf16 v[52:55], a[144:147], a[100:103], v[52:55]
    buffer_load_dwordx4 v27, s[20:23], s59 offen offset:1024  lds
    v_mfma_f32_16x16x32_bf16 v[72:75], a[148:151], a[100:103], v[72:75]
    buffer_load_dwordx4 v236, s[20:23], s59 offen offset:2048  lds
    v_mfma_f32_16x16x32_bf16 v[92:95], a[152:155], a[100:103], v[92:95]
    buffer_load_dwordx4 v237, s[20:23], s59 offen offset:3072  lds
    s_waitcnt vmcnt(15)
    s_waitcnt lgkmcnt(0)
    v_mfma_f32_16x16x32_bf16 v[36:39], a[140:143], a[104:107], v[36:39]
    ds_read_b64_tr_b16 a[156:157], v200 offset:4096
    v_mfma_f32_16x16x32_bf16 v[56:59], a[144:147], a[104:107], v[56:59]
    ds_read_b64_tr_b16 a[158:159], v200 offset:4608
    v_mfma_f32_16x16x32_bf16 v[76:79], a[148:151], a[104:107], v[76:79]
    ds_read_b64_tr_b16 a[160:161], v201 offset:4096
    v_mfma_f32_16x16x32_bf16 v[96:99], a[152:155], a[104:107], v[96:99]
    ds_read_b64_tr_b16 a[162:163], v201 offset:4608
    v_mfma_f32_16x16x32_bf16 v[40:43], a[140:143], a[108:111], v[40:43]
    ds_read_b64_tr_b16 a[164:165], v202 offset:4096
    v_mfma_f32_16x16x32_bf16 v[60:63], a[144:147], a[108:111], v[60:63]
    ds_read_b64_tr_b16 a[166:167], v202 offset:4608
    v_mfma_f32_16x16x32_bf16 v[80:83], a[148:151], a[108:111], v[80:83]
    ds_read_b64_tr_b16 a[168:169], v203 offset:4096
    v_mfma_f32_16x16x32_bf16 v[100:103], a[152:155], a[108:111], v[100:103]
    ds_read_b64_tr_b16 a[170:171], v203 offset:4608
    v_mfma_f32_16x16x32_bf16 v[44:47], a[140:143], a[112:115], v[44:47]
    ds_read_b128 a[120:123], v29 offset:0
    v_mfma_f32_16x16x32_bf16 v[64:67], a[144:147], a[112:115], v[64:67]
    ds_read_b128 a[124:127], v29 offset:2048
    v_mfma_f32_16x16x32_bf16 v[84:87], a[148:151], a[112:115], v[84:87]
    ds_read_b128 a[128:131], v29 offset:4096
    v_mfma_f32_16x16x32_bf16 v[104:107], a[152:155], a[112:115], v[104:107]
    ds_read_b128 a[132:135], v29 offset:6144
    v_mfma_f32_16x16x32_bf16 v[48:51], a[140:143], a[116:119], v[48:51]
    ds_read_b128 a[136:139], v29 offset:8192
    v_mfma_f32_16x16x32_bf16 v[68:71], a[144:147], a[116:119], v[68:71]
    s_lshl_b32 s10, s54, 7
    s_add_u32 m0, s57, 98304
    s_add_u32 s11, s10, 36864
    buffer_load_dwordx4 v24, s[16:19], s10 offen  lds
    v_mfma_f32_16x16x32_bf16 v[88:91], a[148:151], a[116:119], v[88:91]
    s_add_u32 m0, s57, 102400
    s_nop 0
    buffer_load_dwordx4 v24, s[16:19], s11 offen  lds
    v_mfma_f32_16x16x32_bf16 v[108:111], a[152:155], a[116:119], v[108:111]
    s_add_u32 m0, s58, 98304
    s_mov_b32 exec_hi, 0
    buffer_load_dwordx4 v25, s[16:19], s10 offen  lds
    s_mov_b32 exec_hi, -1
    s_lshl_b32 s59, s53, 19
    s_add_u32 s59, s59, 262144
    s_add_u32 m0, s33, 36864
    s_waitcnt lgkmcnt(4)
    v_mfma_f32_16x16x32_bf16 v[32:35], a[156:159], a[120:123], v[32:35]
    buffer_load_dwordx4 v26, s[20:23], s59 offen offset:0  lds
    v_mfma_f32_16x16x32_bf16 v[52:55], a[160:163], a[120:123], v[52:55]
    buffer_load_dwordx4 v27, s[20:23], s59 offen offset:1024  lds
    v_mfma_f32_16x16x32_bf16 v[72:75], a[164:167], a[120:123], v[72:75]
    buffer_load_dwordx4 v236, s[20:23], s59 offen offset:2048  lds
    v_mfma_f32_16x16x32_bf16 v[92:95], a[168:171], a[120:123], v[92:95]
    buffer_load_dwordx4 v237, s[20:23], s59 offen offset:3072  lds
    s_waitcnt vmcnt(18)
    s_waitcnt lgkmcnt(0)
    v_mfma_f32_16x16x32_bf16 v[36:39], a[156:159], a[124:127], v[36:39]
    ds_read_b64_tr_b16 a[140:141], v200 offset:32768
    v_mfma_f32_16x16x32_bf16 v[56:59], a[160:163], a[124:127], v[56:59]
    ds_read_b64_tr_b16 a[142:143], v200 offset:33280
    v_mfma_f32_16x16x32_bf16 v[76:79], a[164:167], a[124:127], v[76:79]
    ds_read_b64_tr_b16 a[144:145], v201 offset:32768
    v_mfma_f32_16x16x32_bf16 v[96:99], a[168:171], a[124:127], v[96:99]
    ds_read_b64_tr_b16 a[146:147], v201 offset:33280
    v_mfma_f32_16x16x32_bf16 v[40:43], a[156:159], a[128:131], v[40:43]
    ds_read_b64_tr_b16 a[148:149], v202 offset:32768
    v_mfma_f32_16x16x32_bf16 v[60:63], a[160:163], a[128:131], v[60:63]
    ds_read_b64_tr_b16 a[150:151], v202 offset:33280
    v_mfma_f32_16x16x32_bf16 v[80:83], a[164:167], a[128:131], v[80:83]
    ds_read_b64_tr_b16 a[152:153], v203 offset:32768
    v_mfma_f32_16x16x32_bf16 v[100:103], a[168:171], a[128:131], v[100:103]
    ds_read_b64_tr_b16 a[154:155], v203 offset:33280
    v_mfma_f32_16x16x32_bf16 v[44:47], a[156:159], a[132:135], v[44:47]
    ds_read_b128 a[100:103], v28 offset:10240
    v_mfma_f32_16x16x32_bf16 v[64:67], a[160:163], a[132:135], v[64:67]
    ds_read_b128 a[104:107], v28 offset:12288
    v_mfma_f32_16x16x32_bf16 v[84:87], a[164:167], a[132:135], v[84:87]
    ds_read_b128 a[108:111], v28 offset:14336
    v_mfma_f32_16x16x32_bf16 v[104:107], a[168:171], a[132:135], v[104:107]
    ds_read_b128 a[112:115], v28 offset:16384
    v_mfma_f32_16x16x32_bf16 v[48:51], a[156:159], a[136:139], v[48:51]
    ds_read_b128 a[116:119], v28 offset:18432
    v_mfma_f32_16x16x32_bf16 v[68:71], a[160:163], a[136:139], v[68:71]
    s_lshl_b32 s59, s54, 19
    v_mfma_f32_16x16x32_bf16 v[88:91], a[164:167], a[136:139], v[88:91]
    s_add_u32 m0, s33, 65536
    v_mfma_f32_16x16x32_bf16 v[108:111], a[168:171], a[136:139], v[108:111]
    s_waitcnt lgkmcnt(4)
    v_mfma_f32_16x16x32_bf16 v[32:35], a[140:143], a[100:103], v[32:35]
    buffer_load_dwordx4 v26, s[20:23], s59 offen offset:0  lds
    v_mfma_f32_16x16x32_bf16 v[52:55], a[144:147], a[100:103], v[52:55]
    buffer_load_dwordx4 v27, s[20:23], s59 offen offset:1024  lds
    v_mfma_f32_16x16x32_bf16 v[72:75], a[148:151], a[100:103], v[72:75]
    buffer_load_dwordx4 v236, s[20:23], s59 offen offset:2048  lds
    v_mfma_f32_16x16x32_bf16 v[92:95], a[152:155], a[100:103], v[92:95]
    buffer_load_dwordx4 v237, s[20:23], s59 offen offset:3072  lds
    s_waitcnt vmcnt(15)
    s_waitcnt lgkmcnt(0)
    v_mfma_f32_16x16x32_bf16 v[36:39], a[140:143], a[104:107], v[36:39]
    ds_read_b64_tr_b16 a[156:157], v200 offset:36864
    v_mfma_f32_16x16x32_bf16 v[56:59], a[144:147], a[104:107], v[56:59]
    ds_read_b64_tr_b16 a[158:159], v200 offset:37376
    v_mfma_f32_16x16x32_bf16 v[76:79], a[148:151], a[104:107], v[76:79]
    ds_read_b64_tr_b16 a[160:161], v201 offset:36864
    v_mfma_f32_16x16x32_bf16 v[96:99], a[152:155], a[104:107], v[96:99]
    ds_read_b64_tr_b16 a[162:163], v201 offset:37376
    v_mfma_f32_16x16x32_bf16 v[40:43], a[140:143], a[108:111], v[40:43]
    ds_read_b64_tr_b16 a[164:165], v202 offset:36864
    v_mfma_f32_16x16x32_bf16 v[60:63], a[144:147], a[108:111], v[60:63]
    ds_read_b64_tr_b16 a[166:167], v202 offset:37376
    v_mfma_f32_16x16x32_bf16 v[80:83], a[148:151], a[108:111], v[80:83]
    ds_read_b64_tr_b16 a[168:169], v203 offset:36864
    v_mfma_f32_16x16x32_bf16 v[100:103], a[152:155], a[108:111], v[100:103]
    ds_read_b64_tr_b16 a[170:171], v203 offset:37376
    v_mfma_f32_16x16x32_bf16 v[44:47], a[140:143], a[112:115], v[44:47]
    ds_read_b128 a[120:123], v29 offset:10240
    v_mfma_f32_16x16x32_bf16 v[64:67], a[144:147], a[112:115], v[64:67]
    ds_read_b128 a[124:127], v29 offset:12288
    v_mfma_f32_16x16x32_bf16 v[84:87], a[148:151], a[112:115], v[84:87]
    ds_read_b128 a[128:131], v29 offset:14336
    v_mfma_f32_16x16x32_bf16 v[104:107], a[152:155], a[112:115], v[104:107]
    ds_read_b128 a[132:135], v29 offset:16384
    v_mfma_f32_16x16x32_bf16 v[48:51], a[140:143], a[116:119], v[48:51]
    ds_read_b128 a[136:139], v29 offset:18432
    v_mfma_f32_16x16x32_bf16 v[68:71], a[144:147], a[116:119], v[68:71]
    s_lshl_b32 s10, s55, 7
    s_add_u32 m0, s57, 108544
    s_add_u32 s11, s10, 36864
    buffer_load_dwordx4 v24, s[16:19], s10 offen  lds
    v_mfma_f32_16x16x32_bf16 v[88:91], a[148:151], a[116:119], v[88:91]
    s_add_u32 m0, s57, 112640
    s_nop 0
    buffer_load_dwordx4 v24, s[16:19], s11 offen  lds
    v_mfma_f32_16x16x32_bf16 v[108:111], a[152:155], a[116:119], v[108:111]
    s_add_u32 m0, s58, 108544
    s_mov_b32 exec_hi, 0
    buffer_load_dwordx4 v25, s[16:19], s10 offen  lds
    s_mov_b32 exec_hi, -1
    s_lshl_b32 s59, s54, 19
    s_add_u32 s59, s59, 262144
    s_add_u32 m0, s33, 69632
    s_waitcnt lgkmcnt(4)
    v_mfma_f32_16x16x32_bf16 v[32:35], a[156:159], a[120:123], v[32:35]
    buffer_load_dwordx4 v26, s[20:23], s59 offen offset:0  lds
    v_mfma_f32_16x16x32_bf16 v[52:55], a[160:163], a[120:123], v[52:55]
    buffer_load_dwordx4 v27, s[20:23], s59 offen offset:1024  lds
    v_mfma_f32_16x16x32_bf16 v[72:75], a[164:167], a[120:123], v[72:75]
    buffer_load_dwordx4 v236, s[20:23], s59 offen offset:2048  lds
    v_mfma_f32_16x16x32_bf16 v[92:95], a[168:171], a[120:123], v[92:95]
    buffer_load_dwordx4 v237, s[20:23], s59 offen offset:3072  lds
    s_waitcnt vmcnt(15)
    s_waitcnt lgkmcnt(0)
    s_barrier
    v_mfma_f32_16x16x32_bf16 v[36:39], a[156:159], a[124:127], v[36:39]
    ds_read_b64_tr_b16 a[140:141], v200 offset:0
    v_mfma_f32_16x16x32_bf16 v[56:59], a[160:163], a[124:127], v[56:59]
    ds_read_b64_tr_b16 a[142:143], v200 offset:512
    v_mfma_f32_16x16x32_bf16 v[76:79], a[164:167], a[124:127], v[76:79]
    ds_read_b64_tr_b16 a[144:145], v201 offset:0
    v_mfma_f32_16x16x32_bf16 v[96:99], a[168:171], a[124:127], v[96:99]
    ds_read_b64_tr_b16 a[146:147], v201 offset:512
    v_mfma_f32_16x16x32_bf16 v[40:43], a[156:159], a[128:131], v[40:43]
    ds_read_b64_tr_b16 a[148:149], v202 offset:0
    v_mfma_f32_16x16x32_bf16 v[60:63], a[160:163], a[128:131], v[60:63]
    ds_read_b64_tr_b16 a[150:151], v202 offset:512
    v_mfma_f32_16x16x32_bf16 v[80:83], a[164:167], a[128:131], v[80:83]
    ds_read_b64_tr_b16 a[152:153], v203 offset:0
    v_mfma_f32_16x16x32_bf16 v[100:103], a[168:171], a[128:131], v[100:103]
    ds_read_b64_tr_b16 a[154:155], v203 offset:512
    v_mfma_f32_16x16x32_bf16 v[44:47], a[156:159], a[132:135], v[44:47]
    ds_read_b128 a[100:103], v28 offset:20480
    v_mfma_f32_16x16x32_bf16 v[64:67], a[160:163], a[132:135], v[64:67]
    ds_read_b128 a[104:107], v28 offset:22528
    v_mfma_f32_16x16x32_bf16 v[84:87], a[164:167], a[132:135], v[84:87]
    ds_read_b128 a[108:111], v28 offset:24576
    v_mfma_f32_16x16x32_bf16 v[104:107], a[168:171], a[132:135], v[104:107]
    ds_read_b128 a[112:115], v28 offset:26624
    v_mfma_f32_16x16x32_bf16 v[48:51], a[156:159], a[136:139], v[48:51]
    ds_read_b128 a[116:119], v28 offset:28672
    v_mfma_f32_16x16x32_bf16 v[68:71], a[160:163], a[136:139], v[68:71]
    s_lshl_b32 s10, s56, 7
    s_add_u32 m0, s57, 118784
    s_add_u32 s11, s10, 36864
    buffer_load_dwordx4 v24, s[16:19], s10 offen  lds
    v_mfma_f32_16x16x32_bf16 v[88:91], a[164:167], a[136:139], v[88:91]
    s_add_u32 m0, s57, 122880
    s_nop 0
    buffer_load_dwordx4 v24, s[16:19], s11 offen  lds
    v_mfma_f32_16x16x32_bf16 v[108:111], a[168:171], a[136:139], v[108:111]
    s_add_u32 m0, s58, 118784
    s_mov_b32 exec_hi, 0
    buffer_load_dwordx4 v25, s[16:19], s10 offen  lds
    s_mov_b32 exec_hi, -1
    s_lshl_b32 s59, s55, 19
    s_add_u32 m0, s33, 32768
    s_waitcnt lgkmcnt(4)
    v_mfma_f32_16x16x32_bf16 v[32:35], a[140:143], a[100:103], v[32:35]
    buffer_load_dwordx4 v26, s[20:23], s59 offen offset:0  lds
    v_mfma_f32_16x16x32_bf16 v[52:55], a[144:147], a[100:103], v[52:55]
    buffer_load_dwordx4 v27, s[20:23], s59 offen offset:1024  lds
    v_mfma_f32_16x16x32_bf16 v[72:75], a[148:151], a[100:103], v[72:75]
    buffer_load_dwordx4 v236, s[20:23], s59 offen offset:2048  lds
    v_mfma_f32_16x16x32_bf16 v[92:95], a[152:155], a[100:103], v[92:95]
    buffer_load_dwordx4 v237, s[20:23], s59 offen offset:3072  lds
    s_waitcnt vmcnt(18)
    s_waitcnt lgkmcnt(0)
    v_mfma_f32_16x16x32_bf16 v[36:39], a[140:143], a[104:107], v[36:39]
    ds_read_b64_tr_b16 a[156:157], v200 offset:4096
    v_mfma_f32_16x16x32_bf16 v[56:59], a[144:147], a[104:107], v[56:59]
    ds_read_b64_tr_b16 a[158:159], v200 offset:4608
    v_mfma_f32_16x16x32_bf16 v[76:79], a[148:151], a[104:107], v[76:79]
    ds_read_b64_tr_b16 a[160:161], v201 offset:4096
    v_mfma_f32_16x16x32_bf16 v[96:99], a[152:155], a[104:107], v[96:99]
    ds_read_b64_tr_b16 a[162:163], v201 offset:4608
    v_mfma_f32_16x16x32_bf16 v[40:43], a[140:143], a[108:111], v[40:43]
    ds_read_b64_tr_b16 a[164:165], v202 offset:4096
    v_mfma_f32_16x16x32_bf16 v[60:63], a[144:147], a[108:111], v[60:63]
    ds_read_b64_tr_b16 a[166:167], v202 offset:4608
    v_mfma_f32_16x16x32_bf16 v[80:83], a[148:151], a[108:111], v[80:83]
    ds_read_b64_tr_b16 a[168:169], v203 offset:4096
    v_mfma_f32_16x16x32_bf16 v[100:103], a[152:155], a[108:111], v[100:103]
    ds_read_b64_tr_b16 a[170:171], v203 offset:4608
    v_mfma_f32_16x16x32_bf16 v[44:47], a[140:143], a[112:115], v[44:47]
    ds_read_b128 a[120:123], v29 offset:20480
    v_mfma_f32_16x16x32_bf16 v[64:67], a[144:147], a[112:115], v[64:67]
    ds_read_b128 a[124:127], v29 offset:22528
    v_mfma_f32_16x16x32_bf16 v[84:87], a[148:151], a[112:115], v[84:87]
    ds_read_b128 a[128:131], v29 offset:24576
    v_mfma_f32_16x16x32_bf16 v[104:107], a[152:155], a[112:115], v[104:107]
    ds_read_b128 a[132:135], v29 offset:26624
    v_mfma_f32_16x16x32_bf16 v[48:51], a[140:143], a[116:119], v[48:51]
    ds_read_b128 a[136:139], v29 offset:28672
    v_mfma_f32_16x16x32_bf16 v[68:71], a[144:147], a[116:119], v[68:71]
    s_lshl_b32 s59, s55, 19
    v_mfma_f32_16x16x32_bf16 v[88:91], a[148:151], a[116:119], v[88:91]
    s_add_u32 s59, s59, 262144
    v_mfma_f32_16x16x32_bf16 v[108:111], a[152:155], a[116:119], v[108:111]
    s_add_u32 m0, s33, 36864
    s_waitcnt lgkmcnt(4)
    v_mfma_f32_16x16x32_bf16 v[32:35], a[156:159], a[120:123], v[32:35]
    buffer_load_dwordx4 v26, s[20:23], s59 offen offset:0  lds
    v_mfma_f32_16x16x32_bf16 v[52:55], a[160:163], a[120:123], v[52:55]
    buffer_load_dwordx4 v27, s[20:23], s59 offen offset:1024  lds
    v_mfma_f32_16x16x32_bf16 v[72:75], a[164:167], a[120:123], v[72:75]
    buffer_load_dwordx4 v236, s[20:23], s59 offen offset:2048  lds
    v_mfma_f32_16x16x32_bf16 v[92:95], a[168:171], a[120:123], v[92:95]
    buffer_load_dwordx4 v237, s[20:23], s59 offen offset:3072  lds
    s_waitcnt vmcnt(18)
    s_waitcnt lgkmcnt(0)
    v_mfma_f32_16x16x32_bf16 v[36:39], a[156:159], a[124:127], v[36:39]
    ds_read_b64_tr_b16 a[140:141], v200 offset:32768
    v_mfma_f32_16x16x32_bf16 v[56:59], a[160:163], a[124:127], v[56:59]
    ds_read_b64_tr_b16 a[142:143], v200 offset:33280
    v_mfma_f32_16x16x32_bf16 v[76:79], a[164:167], a[124:127], v[76:79]
    ds_read_b64_tr_b16 a[144:145], v201 offset:32768
    v_mfma_f32_16x16x32_bf16 v[96:99], a[168:171], a[124:127], v[96:99]
    ds_read_b64_tr_b16 a[146:147], v201 offset:33280
    v_mfma_f32_16x16x32_bf16 v[40:43], a[156:159], a[128:131], v[40:43]
    ds_read_b64_tr_b16 a[148:149], v202 offset:32768
    v_mfma_f32_16x16x32_bf16 v[60:63], a[160:163], a[128:131], v[60:63]
    ds_read_b64_tr_b16 a[150:151], v202 offset:33280
    v_mfma_f32_16x16x32_bf16 v[80:83], a[164:167], a[128:131], v[80:83]
    ds_read_b64_tr_b16 a[152:153], v203 offset:32768
    v_mfma_f32_16x16x32_bf16 v[100:103], a[168:171], a[128:131], v[100:103]
    ds_read_b64_tr_b16 a[154:155], v203 offset:33280
    v_mfma_f32_16x16x32_bf16 v[44:47], a[156:159], a[132:135], v[44:47]
    ds_read_b128 a[100:103], v30 offset:0
    v_mfma_f32_16x16x32_bf16 v[64:67], a[160:163], a[132:135], v[64:67]
    ds_read_b128 a[104:107], v30 offset:2048
    v_mfma_f32_16x16x32_bf16 v[84:87], a[164:167], a[132:135], v[84:87]
    ds_read_b128 a[108:111], v30 offset:4096
    v_mfma_f32_16x16x32_bf16 v[104:107], a[168:171], a[132:135], v[104:107]
    ds_read_b128 a[112:115], v30 offset:6144
    v_mfma_f32_16x16x32_bf16 v[48:51], a[156:159], a[136:139], v[48:51]
    ds_read_b128 a[116:119], v30 offset:8192
    v_mfma_f32_16x16x32_bf16 v[68:71], a[160:163], a[136:139], v[68:71]
    s_lshl_b32 s59, s56, 19
    v_mfma_f32_16x16x32_bf16 v[88:91], a[164:167], a[136:139], v[88:91]
    s_add_u32 m0, s33, 65536
    v_mfma_f32_16x16x32_bf16 v[108:111], a[168:171], a[136:139], v[108:111]
    s_waitcnt lgkmcnt(4)
    v_mfma_f32_16x16x32_bf16 v[32:35], a[140:143], a[100:103], v[32:35]
    buffer_load_dwordx4 v26, s[20:23], s59 offen offset:0  lds
    v_mfma_f32_16x16x32_bf16 v[52:55], a[144:147], a[100:103], v[52:55]
    buffer_load_dwordx4 v27, s[20:23], s59 offen offset:1024  lds
    v_mfma_f32_16x16x32_bf16 v[72:75], a[148:151], a[100:103], v[72:75]
    buffer_load_dwordx4 v236, s[20:23], s59 offen offset:2048  lds
    v_mfma_f32_16x16x32_bf16 v[92:95], a[152:155], a[100:103], v[92:95]
    buffer_load_dwordx4 v237, s[20:23], s59 offen offset:3072  lds
    s_waitcnt vmcnt(15)
    s_waitcnt lgkmcnt(0)
    v_mfma_f32_16x16x32_bf16 v[36:39], a[140:143], a[104:107], v[36:39]
    ds_read_b64_tr_b16 a[156:157], v200 offset:36864
    v_mfma_f32_16x16x32_bf16 v[56:59], a[144:147], a[104:107], v[56:59]
    ds_read_b64_tr_b16 a[158:159], v200 offset:37376
    v_mfma_f32_16x16x32_bf16 v[76:79], a[148:151], a[104:107], v[76:79]
    ds_read_b64_tr_b16 a[160:161], v201 offset:36864
    v_mfma_f32_16x16x32_bf16 v[96:99], a[152:155], a[104:107], v[96:99]
    ds_read_b64_tr_b16 a[162:163], v201 offset:37376
    v_mfma_f32_16x16x32_bf16 v[40:43], a[140:143], a[108:111], v[40:43]
    ds_read_b64_tr_b16 a[164:165], v202 offset:36864
    v_mfma_f32_16x16x32_bf16 v[60:63], a[144:147], a[108:111], v[60:63]
    ds_read_b64_tr_b16 a[166:167], v202 offset:37376
    v_mfma_f32_16x16x32_bf16 v[80:83], a[148:151], a[108:111], v[80:83]
    ds_read_b64_tr_b16 a[168:169], v203 offset:36864
    v_mfma_f32_16x16x32_bf16 v[100:103], a[152:155], a[108:111], v[100:103]
    ds_read_b64_tr_b16 a[170:171], v203 offset:37376
    v_mfma_f32_16x16x32_bf16 v[44:47], a[140:143], a[112:115], v[44:47]
    ds_read_b128 a[120:123], v31 offset:0
    v_mfma_f32_16x16x32_bf16 v[64:67], a[144:147], a[112:115], v[64:67]
    ds_read_b128 a[124:127], v31 offset:2048
    v_mfma_f32_16x16x32_bf16 v[84:87], a[148:151], a[112:115], v[84:87]
    ds_read_b128 a[128:131], v31 offset:4096
    v_mfma_f32_16x16x32_bf16 v[104:107], a[152:155], a[112:115], v[104:107]
    ds_read_b128 a[132:135], v31 offset:6144
    v_mfma_f32_16x16x32_bf16 v[48:51], a[140:143], a[116:119], v[48:51]
    ds_read_b128 a[136:139], v31 offset:8192
    v_mfma_f32_16x16x32_bf16 v[68:71], a[144:147], a[116:119], v[68:71]
    s_lshl_b32 s59, s56, 19
    v_mfma_f32_16x16x32_bf16 v[88:91], a[148:151], a[116:119], v[88:91]
    s_add_u32 s59, s59, 262144
    v_mfma_f32_16x16x32_bf16 v[108:111], a[152:155], a[116:119], v[108:111]
    s_add_u32 m0, s33, 69632
    s_waitcnt lgkmcnt(4)
    v_mfma_f32_16x16x32_bf16 v[32:35], a[156:159], a[120:123], v[32:35]
    buffer_load_dwordx4 v26, s[20:23], s59 offen offset:0  lds
    v_mfma_f32_16x16x32_bf16 v[52:55], a[160:163], a[120:123], v[52:55]
    buffer_load_dwordx4 v27, s[20:23], s59 offen offset:1024  lds
    v_mfma_f32_16x16x32_bf16 v[72:75], a[164:167], a[120:123], v[72:75]
    buffer_load_dwordx4 v236, s[20:23], s59 offen offset:2048  lds
    v_mfma_f32_16x16x32_bf16 v[92:95], a[168:171], a[120:123], v[92:95]
    buffer_load_dwordx4 v237, s[20:23], s59 offen offset:3072  lds
    s_waitcnt vmcnt(12)
    s_waitcnt lgkmcnt(0)
    s_barrier
    v_mfma_f32_16x16x32_bf16 v[36:39], a[156:159], a[124:127], v[36:39]
    ds_read_b64_tr_b16 a[140:141], v200 offset:0
    v_mfma_f32_16x16x32_bf16 v[56:59], a[160:163], a[124:127], v[56:59]
    ds_read_b64_tr_b16 a[142:143], v200 offset:512
    v_mfma_f32_16x16x32_bf16 v[76:79], a[164:167], a[124:127], v[76:79]
    ds_read_b64_tr_b16 a[144:145], v201 offset:0
    v_mfma_f32_16x16x32_bf16 v[96:99], a[168:171], a[124:127], v[96:99]
    ds_read_b64_tr_b16 a[146:147], v201 offset:512
    v_mfma_f32_16x16x32_bf16 v[40:43], a[156:159], a[128:131], v[40:43]
    ds_read_b64_tr_b16 a[148:149], v202 offset:0
    v_mfma_f32_16x16x32_bf16 v[60:63], a[160:163], a[128:131], v[60:63]
    ds_read_b64_tr_b16 a[150:151], v202 offset:512
    v_mfma_f32_16x16x32_bf16 v[80:83], a[164:167], a[128:131], v[80:83]
    ds_read_b64_tr_b16 a[152:153], v203 offset:0
    v_mfma_f32_16x16x32_bf16 v[100:103], a[168:171], a[128:131], v[100:103]
    ds_read_b64_tr_b16 a[154:155], v203 offset:512
    v_mfma_f32_16x16x32_bf16 v[44:47], a[156:159], a[132:135], v[44:47]
    ds_read_b128 a[100:103], v30 offset:10240
    v_mfma_f32_16x16x32_bf16 v[64:67], a[160:163], a[132:135], v[64:67]
    ds_read_b128 a[104:107], v30 offset:12288
    v_mfma_f32_16x16x32_bf16 v[84:87], a[164:167], a[132:135], v[84:87]
    ds_read_b128 a[108:111], v30 offset:14336
    v_mfma_f32_16x16x32_bf16 v[104:107], a[168:171], a[132:135], v[104:107]
    ds_read_b128 a[112:115], v30 offset:16384
    v_mfma_f32_16x16x32_bf16 v[48:51], a[156:159], a[136:139], v[48:51]
    ds_read_b128 a[116:119], v30 offset:18432
    v_mfma_f32_16x16x32_bf16 v[68:71], a[160:163], a[136:139], v[68:71]
    s_add_u32 s59, s32, 0
    v_mfma_f32_16x16x32_bf16 v[88:91], a[164:167], a[136:139], v[88:91]
    s_add_u32 m0, s33, 131072
    v_mfma_f32_16x16x32_bf16 v[108:111], a[168:171], a[136:139], v[108:111]
    s_waitcnt lgkmcnt(4)
    v_mfma_f32_16x16x32_bf16 v[32:35], a[140:143], a[100:103], v[32:35]
    buffer_load_dwordx4 v4, s[12:15], s59 offen offset:0 nt lds
    v_mfma_f32_16x16x32_bf16 v[52:55], a[144:147], a[100:103], v[52:55]
    buffer_load_dwordx4 v5, s[12:15], s59 offen offset:1024 nt lds
    v_mfma_f32_16x16x32_bf16 v[72:75], a[148:151], a[100:103], v[72:75]
    buffer_load_dwordx4 v6, s[12:15], s59 offen offset:2048 nt lds
    v_mfma_f32_16x16x32_bf16 v[92:95], a[152:155], a[100:103], v[92:95]
    buffer_load_dwordx4 v7, s[12:15], s59 offen offset:3072 nt lds
    s_waitcnt vmcnt(12)
    s_waitcnt lgkmcnt(0)
    v_mfma_f32_16x16x32_bf16 v[36:39], a[140:143], a[104:107], v[36:39]
    ds_read_b64_tr_b16 a[156:157], v200 offset:4096
    v_mfma_f32_16x16x32_bf16 v[56:59], a[144:147], a[104:107], v[56:59]
    ds_read_b64_tr_b16 a[158:159], v200 offset:4608
    v_mfma_f32_16x16x32_bf16 v[76:79], a[148:151], a[104:107], v[76:79]
    ds_read_b64_tr_b16 a[160:161], v201 offset:4096
    v_mfma_f32_16x16x32_bf16 v[96:99], a[152:155], a[104:107], v[96:99]
    ds_read_b64_tr_b16 a[162:163], v201 offset:4608
    v_mfma_f32_16x16x32_bf16 v[40:43], a[140:143], a[108:111], v[40:43]
    ds_read_b64_tr_b16 a[164:165], v202 offset:4096
    v_mfma_f32_16x16x32_bf16 v[60:63], a[144:147], a[108:111], v[60:63]
    ds_read_b64_tr_b16 a[166:167], v202 offset:4608
    v_mfma_f32_16x16x32_bf16 v[80:83], a[148:151], a[108:111], v[80:83]
    ds_read_b64_tr_b16 a[168:169], v203 offset:4096
    v_mfma_f32_16x16x32_bf16 v[100:103], a[152:155], a[108:111], v[100:103]
    ds_read_b64_tr_b16 a[170:171], v203 offset:4608
    v_mfma_f32_16x16x32_bf16 v[44:47], a[140:143], a[112:115], v[44:47]
    ds_read_b128 a[120:123], v31 offset:10240
    v_mfma_f32_16x16x32_bf16 v[64:67], a[144:147], a[112:115], v[64:67]
    ds_read_b128 a[124:127], v31 offset:12288
    v_mfma_f32_16x16x32_bf16 v[84:87], a[148:151], a[112:115], v[84:87]
    ds_read_b128 a[128:131], v31 offset:14336
    v_mfma_f32_16x16x32_bf16 v[104:107], a[152:155], a[112:115], v[104:107]
    ds_read_b128 a[132:135], v31 offset:16384
    v_mfma_f32_16x16x32_bf16 v[48:51], a[140:143], a[116:119], v[48:51]
    ds_read_b128 a[136:139], v31 offset:18432
    v_mfma_f32_16x16x32_bf16 v[68:71], a[144:147], a[116:119], v[68:71]
    s_add_u32 s59, s32, 4096
    v_mfma_f32_16x16x32_bf16 v[88:91], a[148:151], a[116:119], v[88:91]
    s_add_u32 m0, s33, 135168
    v_mfma_f32_16x16x32_bf16 v[108:111], a[152:155], a[116:119], v[108:111]
    s_waitcnt lgkmcnt(4)
    v_mfma_f32_16x16x32_bf16 v[32:35], a[156:159], a[120:123], v[32:35]
    buffer_load_dwordx4 v4, s[12:15], s59 offen offset:0 nt lds
    v_mfma_f32_16x16x32_bf16 v[52:55], a[160:163], a[120:123], v[52:55]
    buffer_load_dwordx4 v5, s[12:15], s59 offen offset:1024 nt lds
    v_mfma_f32_16x16x32_bf16 v[72:75], a[164:167], a[120:123], v[72:75]
    buffer_load_dwordx4 v6, s[12:15], s59 offen offset:2048 nt lds
    v_mfma_f32_16x16x32_bf16 v[92:95], a[168:171], a[120:123], v[92:95]
    buffer_load_dwordx4 v7, s[12:15], s59 offen offset:3072 nt lds
    s_waitcnt vmcnt(12)
    s_waitcnt lgkmcnt(0)
    v_mfma_f32_16x16x32_bf16 v[36:39], a[156:159], a[124:127], v[36:39]
    ds_read_b64_tr_b16 a[140:141], v200 offset:32768
    v_mfma_f32_16x16x32_bf16 v[56:59], a[160:163], a[124:127], v[56:59]
    ds_read_b64_tr_b16 a[142:143], v200 offset:33280
    v_mfma_f32_16x16x32_bf16 v[76:79], a[164:167], a[124:127], v[76:79]
    ds_read_b64_tr_b16 a[144:145], v201 offset:32768
    v_mfma_f32_16x16x32_bf16 v[96:99], a[168:171], a[124:127], v[96:99]
    ds_read_b64_tr_b16 a[146:147], v201 offset:33280
    v_mfma_f32_16x16x32_bf16 v[40:43], a[156:159], a[128:131], v[40:43]
    ds_read_b64_tr_b16 a[148:149], v202 offset:32768
    v_mfma_f32_16x16x32_bf16 v[60:63], a[160:163], a[128:131], v[60:63]
    ds_read_b64_tr_b16 a[150:151], v202 offset:33280
    v_mfma_f32_16x16x32_bf16 v[80:83], a[164:167], a[128:131], v[80:83]
    ds_read_b64_tr_b16 a[152:153], v203 offset:32768
    v_mfma_f32_16x16x32_bf16 v[100:103], a[168:171], a[128:131], v[100:103]
    ds_read_b64_tr_b16 a[154:155], v203 offset:33280
    v_mfma_f32_16x16x32_bf16 v[44:47], a[156:159], a[132:135], v[44:47]
    ds_read_b128 a[100:103], v30 offset:20480
    v_mfma_f32_16x16x32_bf16 v[64:67], a[160:163], a[132:135], v[64:67]
    ds_read_b128 a[104:107], v30 offset:22528
    v_mfma_f32_16x16x32_bf16 v[84:87], a[164:167], a[132:135], v[84:87]
    ds_read_b128 a[108:111], v30 offset:24576
    v_mfma_f32_16x16x32_bf16 v[104:107], a[168:171], a[132:135], v[104:107]
    ds_read_b128 a[112:115], v30 offset:26624
    v_mfma_f32_16x16x32_bf16 v[48:51], a[156:159], a[136:139], v[48:51]
    ds_read_b128 a[116:119], v30 offset:28672
    v_mfma_f32_16x16x32_bf16 v[68:71], a[160:163], a[136:139], v[68:71]
    v_mfma_f32_16x16x32_bf16 v[88:91], a[164:167], a[136:139], v[88:91]
    v_mfma_f32_16x16x32_bf16 v[108:111], a[168:171], a[136:139], v[108:111]
    s_waitcnt vmcnt(8)
    s_waitcnt lgkmcnt(0)
    v_mfma_f32_16x16x32_bf16 v[32:35], a[140:143], a[100:103], v[32:35]
    ds_read_b64_tr_b16 a[156:157], v200 offset:36864
    ds_read_b64_tr_b16 a[158:159], v200 offset:37376
    v_mfma_f32_16x16x32_bf16 v[52:55], a[144:147], a[100:103], v[52:55]
    ds_read_b64_tr_b16 a[160:161], v201 offset:36864
    ds_read_b64_tr_b16 a[162:163], v201 offset:37376
    v_mfma_f32_16x16x32_bf16 v[72:75], a[148:151], a[100:103], v[72:75]
    ds_read_b64_tr_b16 a[164:165], v202 offset:36864
    ds_read_b64_tr_b16 a[166:167], v202 offset:37376
    v_mfma_f32_16x16x32_bf16 v[92:95], a[152:155], a[100:103], v[92:95]
    ds_read_b64_tr_b16 a[168:169], v203 offset:36864
    v_mfma_f32_16x16x32_bf16 v[36:39], a[140:143], a[104:107], v[36:39]
    ds_read_b64_tr_b16 a[170:171], v203 offset:37376
    ds_read_b128 a[120:123], v31 offset:20480
    v_mfma_f32_16x16x32_bf16 v[56:59], a[144:147], a[104:107], v[56:59]
    ds_read_b128 a[124:127], v31 offset:22528
    ds_read_b128 a[128:131], v31 offset:24576
    v_mfma_f32_16x16x32_bf16 v[76:79], a[148:151], a[104:107], v[76:79]
    ds_read_b128 a[132:135], v31 offset:26624
    ds_read_b128 a[136:139], v31 offset:28672
    v_mfma_f32_16x16x32_bf16 v[96:99], a[152:155], a[104:107], v[96:99]
    v_mfma_f32_16x16x32_bf16 v[40:43], a[140:143], a[108:111], v[40:43]
    v_mfma_f32_16x16x32_bf16 v[60:63], a[144:147], a[108:111], v[60:63]
    v_mfma_f32_16x16x32_bf16 v[80:83], a[148:151], a[108:111], v[80:83]
    v_mfma_f32_16x16x32_bf16 v[100:103], a[152:155], a[108:111], v[100:103]
    s_waitcnt lgkmcnt(0)
    s_barrier
    s_add_u32 s59, s32, 16384
    s_add_u32 m0, s33, 0
    v_mfma_f32_16x16x32_bf16 v[32:35], a[156:159], a[120:123], v[32:35]
    buffer_load_dwordx4 v4, s[12:15], s59 offen offset:0 nt lds
    v_mfma_f32_16x16x32_bf16 v[52:55], a[160:163], a[120:123], v[52:55]
    buffer_load_dwordx4 v5, s[12:15], s59 offen offset:1024 nt lds
    v_mfma_f32_16x16x32_bf16 v[72:75], a[164:167], a[120:123], v[72:75]
    buffer_load_dwordx4 v6, s[12:15], s59 offen offset:2048 nt lds
    v_mfma_f32_16x16x32_bf16 v[92:95], a[168:171], a[120:123], v[92:95]
    buffer_load_dwordx4 v7, s[12:15], s59 offen offset:3072 nt lds
    v_mfma_f32_16x16x32_bf16 v[36:39], a[156:159], a[124:127], v[36:39]
    v_mfma_f32_16x16x32_bf16 v[56:59], a[160:163], a[124:127], v[56:59]
    v_mul_f32 v32, s40, v32
    v_mul_f32 v33, s40, v33
    v_mul_f32 v34, s40, v34
    v_mfma_f32_16x16x32_bf16 v[76:79], a[164:167], a[124:127], v[76:79]
    v_mul_f32 v35, s40, v35
    v_cvt_pk_bf16_f32 v32, v32, v33
    v_cvt_pk_bf16_f32 v33, v34, v35
    v_mfma_f32_16x16x32_bf16 v[96:99], a[168:171], a[124:127], v[96:99]
    ds_write_b64 v198, v[32:33] offset:0
    v_mul_f32 v52, s40, v52
    v_mul_f32 v53, s40, v53
    v_mfma_f32_16x16x32_bf16 v[40:43], a[156:159], a[128:131], v[40:43]
    v_mul_f32 v54, s40, v54
    v_mul_f32 v55, s40, v55
    v_cvt_pk_bf16_f32 v52, v52, v53
    v_mfma_f32_16x16x32_bf16 v[60:63], a[160:163], a[128:131], v[60:63]
    v_cvt_pk_bf16_f32 v53, v54, v55
    ds_write_b64 v198, v[52:53] offset:512
    v_mul_f32 v72, s40, v72
    v_mfma_f32_16x16x32_bf16 v[80:83], a[164:167], a[128:131], v[80:83]
    v_mul_f32 v73, s40, v73
    v_mul_f32 v74, s40, v74
    v_mul_f32 v75, s40, v75
    v_mfma_f32_16x16x32_bf16 v[100:103], a[168:171], a[128:131], v[100:103]
    v_cvt_pk_bf16_f32 v72, v72, v73
    v_cvt_pk_bf16_f32 v73, v74, v75
    ds_write_b64 v198, v[72:73] offset:1024
    v_mfma_f32_16x16x32_bf16 v[44:47], a[140:143], a[112:115], v[44:47]
    v_mul_f32 v92, s40, v92
    v_mul_f32 v93, s40, v93
    v_mul_f32 v94, s40, v94
    v_mfma_f32_16x16x32_bf16 v[64:67], a[144:147], a[112:115], v[64:67]
    v_mul_f32 v95, s40, v95
    v_cvt_pk_bf16_f32 v92, v92, v93
    v_cvt_pk_bf16_f32 v93, v94, v95
    v_mfma_f32_16x16x32_bf16 v[84:87], a[148:151], a[112:115], v[84:87]
    ds_write_b64 v198, v[92:93] offset:1536
    v_mul_f32 v36, s40, v36
    v_mul_f32 v37, s40, v37
    v_mfma_f32_16x16x32_bf16 v[104:107], a[152:155], a[112:115], v[104:107]
    v_mul_f32 v38, s40, v38
    v_mul_f32 v39, s40, v39
    v_cvt_pk_bf16_f32 v36, v36, v37
    v_mfma_f32_16x16x32_bf16 v[44:47], a[156:159], a[132:135], v[44:47]
    v_cvt_pk_bf16_f32 v37, v38, v39
    ds_write_b64 v198, v[36:37] offset:4096
    v_mul_f32 v56, s40, v56
    v_mfma_f32_16x16x32_bf16 v[64:67], a[160:163], a[132:135], v[64:67]
    v_mul_f32 v57, s40, v57
    v_mul_f32 v58, s40, v58
    v_mul_f32 v59, s40, v59
    v_mfma_f32_16x16x32_bf16 v[84:87], a[164:167], a[132:135], v[84:87]
    v_cvt_pk_bf16_f32 v56, v56, v57
    v_cvt_pk_bf16_f32 v57, v58, v59
    ds_write_b64 v198, v[56:57] offset:4608
    v_mfma_f32_16x16x32_bf16 v[104:107], a[168:171], a[132:135], v[104:107]
    v_mul_f32 v76, s40, v76
    v_mul_f32 v77, s40, v77
    v_mul_f32 v78, s40, v78
    v_mfma_f32_16x16x32_bf16 v[48:51], a[140:143], a[116:119], v[48:51]
    v_mul_f32 v79, s40, v79
    v_cvt_pk_bf16_f32 v76, v76, v77
    v_cvt_pk_bf16_f32 v77, v78, v79
    v_mfma_f32_16x16x32_bf16 v[68:71], a[144:147], a[116:119], v[68:71]
    ds_write_b64 v198, v[76:77] offset:5120
    v_mul_f32 v96, s40, v96
    v_mul_f32 v97, s40, v97
    v_mfma_f32_16x16x32_bf16 v[88:91], a[148:151], a[116:119], v[88:91]
    v_mul_f32 v98, s40, v98
    v_mul_f32 v99, s40, v99
    v_cvt_pk_bf16_f32 v96, v96, v97
    v_mfma_f32_16x16x32_bf16 v[108:111], a[152:155], a[116:119], v[108:111]
    v_cvt_pk_bf16_f32 v97, v98, v99
    ds_write_b64 v198, v[96:97] offset:5632
    v_mul_f32 v40, s40, v40
    v_mfma_f32_16x16x32_bf16 v[48:51], a[156:159], a[136:139], v[48:51]
    v_mul_f32 v41, s40, v41
    v_mul_f32 v42, s40, v42
    v_mul_f32 v43, s40, v43
    v_mfma_f32_16x16x32_bf16 v[68:71], a[160:163], a[136:139], v[68:71]
    v_cvt_pk_bf16_f32 v40, v40, v41
    v_cvt_pk_bf16_f32 v41, v42, v43
    ds_write_b64 v198, v[40:41] offset:8192
    v_mfma_f32_16x16x32_bf16 v[88:91], a[164:167], a[136:139], v[88:91]
    v_mul_f32 v60, s40, v60
    v_mul_f32 v61, s40, v61
    v_mul_f32 v62, s40, v62
    v_mfma_f32_16x16x32_bf16 v[108:111], a[168:171], a[136:139], v[108:111]
    v_mul_f32 v63, s40, v63
    v_cvt_pk_bf16_f32 v60, v60, v61
    v_cvt_pk_bf16_f32 v61, v62, v63
    ds_write_b64 v198, v[60:61] offset:8704
    v_mul_f32 v80, s40, v80
    v_mul_f32 v81, s40, v81
    v_mul_f32 v82, s40, v82
    v_mul_f32 v83, s40, v83
    v_cvt_pk_bf16_f32 v80, v80, v81
    v_cvt_pk_bf16_f32 v81, v82, v83
    ds_write_b64 v198, v[80:81] offset:9216
    v_mul_f32 v100, s40, v100
    v_mul_f32 v101, s40, v101
    v_mul_f32 v102, s40, v102
    v_mul_f32 v103, s40, v103
    v_cvt_pk_bf16_f32 v100, v100, v101
    v_cvt_pk_bf16_f32 v101, v102, v103
    ds_write_b64 v198, v[100:101] offset:9728
    v_mul_f32 v44, s40, v44
    v_mul_f32 v45, s40, v45
    v_mul_f32 v46, s40, v46
    v_mul_f32 v47, s40, v47
    v_cvt_pk_bf16_f32 v44, v44, v45
    v_cvt_pk_bf16_f32 v45, v46, v47
    ds_write_b64 v198, v[44:45] offset:12288
    v_mul_f32 v64, s40, v64
    v_mul_f32 v65, s40, v65
    v_mul_f32 v66, s40, v66
    v_mul_f32 v67, s40, v67
    v_cvt_pk_bf16_f32 v64, v64, v65
    v_cvt_pk_bf16_f32 v65, v66, v67
    ds_write_b64 v198, v[64:65] offset:12800
    v_mul_f32 v84, s40, v84
    v_mul_f32 v85, s40, v85
    v_mul_f32 v86, s40, v86
    v_mul_f32 v87, s40, v87
    v_cvt_pk_bf16_f32 v84, v84, v85
    v_cvt_pk_bf16_f32 v85, v86, v87
    ds_write_b64 v198, v[84:85] offset:13312
    v_mul_f32 v104, s40, v104
    v_mul_f32 v105, s40, v105
    v_mul_f32 v106, s40, v106
    v_mul_f32 v107, s40, v107
    v_cvt_pk_bf16_f32 v104, v104, v105
    v_cvt_pk_bf16_f32 v105, v106, v107
    ds_write_b64 v198, v[104:105] offset:13824
    v_mul_f32 v48, s40, v48
    v_mul_f32 v49, s40, v49
    v_mul_f32 v50, s40, v50
    v_mul_f32 v51, s40, v51
    v_cvt_pk_bf16_f32 v48, v48, v49
    v_cvt_pk_bf16_f32 v49, v50, v51
    ds_write_b64 v244, v[48:49] offset:0
    v_mul_f32 v68, s40, v68
    v_mul_f32 v69, s40, v69
    v_mul_f32 v70, s40, v70
    v_mul_f32 v71, s40, v71
    v_cvt_pk_bf16_f32 v68, v68, v69
    v_cvt_pk_bf16_f32 v69, v70, v71
    ds_write_b64 v244, v[68:69] offset:512
    v_mul_f32 v88, s40, v88
    v_mul_f32 v89, s40, v89
    v_mul_f32 v90, s40, v90
    v_mul_f32 v91, s40, v91
    v_cvt_pk_bf16_f32 v88, v88, v89
    v_cvt_pk_bf16_f32 v89, v90, v91
    ds_write_b64 v244, v[88:89] offset:1024
    v_mul_f32 v108, s40, v108
    v_mul_f32 v109, s40, v109
    v_mul_f32 v110, s40, v110
    v_mul_f32 v111, s40, v111
    v_cvt_pk_bf16_f32 v108, v108, v109
    v_cvt_pk_bf16_f32 v109, v110, v111
    ds_write_b64 v244, v[108:109] offset:1536
    s_add_u32 s59, s32, 20480
    s_add_u32 m0, s33, 4096
    s_nop 0
    buffer_load_dwordx4 v4, s[12:15], s59 offen offset:0 nt lds
    buffer_load_dwordx4 v5, s[12:15], s59 offen offset:1024 nt lds
    buffer_load_dwordx4 v6, s[12:15], s59 offen offset:2048 nt lds
    buffer_load_dwordx4 v7, s[12:15], s59 offen offset:3072 nt lds
    s_mov_b32 s48, s4
    s_add_u32 s49, s48, 1
    s_cmp_eq_u32 s49, 9
    s_cselect_b32 s49, 0, s49
    s_add_u32 s50, s49, 1
    s_cmp_eq_u32 s50, 9
    s_cselect_b32 s50, 0, s50
    s_add_u32 s51, s50, 1
    s_cmp_eq_u32 s51, 9
    s_cselect_b32 s51, 0, s51
    s_add_u32 s52, s51, 1
    s_cmp_eq_u32 s52, 9
    s_cselect_b32 s52, 0, s52
    s_add_u32 s53, s52, 1
    s_cmp_eq_u32 s53, 9
    s_cselect_b32 s53, 0, s53
    s_add_u32 s54, s53, 1
    s_cmp_eq_u32 s54, 9
    s_cselect_b32 s54, 0, s54
    s_add_u32 s55, s54, 1
    s_cmp_eq_u32 s55, 9
    s_cselect_b32 s55, 0, s55
    s_add_u32 s56, s55, 1
    s_cmp_eq_u32 s56, 9
    s_cselect_b32 s56, 0, s56
    s_waitcnt vmcnt(8)
    s_waitcnt lgkmcnt(0)
    s_barrier
    ds_read_b128 a[100:103], v8 offset:0
    ds_read_b128 a[104:107], v9 offset:0
    ds_read_b128 a[108:111], v10 offset:0
    ds_read_b128 a[112:115], v11 offset:0
    ds_read_b128 a[164:167], v199 offset:32768
    ds_read_b128 a[168:171], v199 offset:33792
    ds_read_b128 a[172:175], v199 offset:34816
    ds_read_b128 a[176:179], v199 offset:35840
    ds_read_b128 a[180:183], v199 offset:36864
    ds_read_b128 a[184:187], v199 offset:37888
    ds_read_b128 a[188:191], v199 offset:38912
    ds_read_b128 a[192:195], v199 offset:39936
    ds_read_b128 a[196:199], v199 offset:40960
    ds_read_b128 a[200:203], v199 offset:41984
    ds_read_b128 a[204:207], v199 offset:43008
    ds_read_b128 a[208:211], v199 offset:44032
    ds_read_b128 a[212:215], v199 offset:45056
    ds_read_b128 a[216:219], v199 offset:46080
    ds_read_b128 a[220:223], v199 offset:47104
    ds_read_b128 a[224:227], v199 offset:48128
    ds_read_b128 a[228:231], v199 offset:0
    ds_read_b128 a[232:235], v199 offset:1024
    ds_read_b128 a[236:239], v199 offset:8192
    ds_read_b128 a[240:243], v199 offset:9216
    ds_read_b128 a[116:119], v8 offset:4096
    ds_read_b128 a[120:123], v9 offset:4096
    ds_read_b128 a[124:127], v10 offset:4096
    ds_read_b128 a[128:131], v11 offset:4096
    s_mov_b32 s11, s36
    s_waitcnt lgkmcnt(12)
    v_mfma_f32_16x16x32_bf16 v[52:55], a[100:103], a[164:167], 0
    v_add_u32 v8, s11, v8
    v_add_u32 v9, s11, v9
    v_mfma_f32_16x16x32_bf16 v[52:55], a[104:107], a[168:171], v[52:55]
    v_add_u32 v10, s11, v10
    v_mfma_f32_16x16x32_bf16 v[52:55], a[108:111], a[172:175], v[52:55]
    s_add_u32 s45, s33, 32768
    s_add_u32 s32, s32, 32768
    s_mov_b32 m0, s45
    v_mfma_f32_16x16x32_bf16 v[52:55], a[112:115], a[176:179], v[52:55]
    s_mov_b32 s37, 16384
    s_mov_b32 s43, 32768
    v_mfma_f32_16x16x32_bf16 v[60:63], a[100:103], a[180:183], 0
    v_mfma_f32_16x16x32_bf16 v[60:63], a[104:107], a[184:187], v[60:63]
    v_mfma_f32_16x16x32_bf16 v[60:63], a[108:111], a[188:191], v[60:63]
    v_mfma_f32_16x16x32_bf16 v[60:63], a[112:115], a[192:195], v[60:63]
    s_waitcnt lgkmcnt(0)
    v_mfma_f32_16x16x32_bf16 v[68:71], a[100:103], a[196:199], 0
    ds_read_b64_tr_b16 a[132:133], v12 offset:0
    v_mfma_f32_16x16x32_bf16 v[68:71], a[104:107], a[200:203], v[68:71]
    ds_read_b64_tr_b16 a[134:135], v12 offset:4096
    v_mfma_f32_16x16x32_bf16 v[68:71], a[108:111], a[204:207], v[68:71]
    ds_read_b64_tr_b16 a[136:137], v13 offset:0
    v_max3_f32 v52, v52, v53, v54
    v_max_f32 v52, v52, v55
    v_mfma_f32_16x16x32_bf16 v[68:71], a[112:115], a[208:211], v[68:71]
    ds_read_b64_tr_b16 a[138:139], v13 offset:4096
    v_mov_b32 v53, v52
    s_nop 0
    v_mfma_f32_16x16x32_bf16 v[76:79], a[100:103], a[212:215], 0
    ds_read_b64_tr_b16 a[140:141], v14 offset:0
    v_permlane32_swap_b32 v52, v53
    v_max_f32 v52, v52, v53
    v_mfma_f32_16x16x32_bf16 v[76:79], a[104:107], a[216:219], v[76:79]
    ds_read_b64_tr_b16 a[142:143], v14 offset:4096
    v_mov_b32 v53, v52
    s_nop 0
    v_mfma_f32_16x16x32_bf16 v[76:79], a[108:111], a[220:223], v[76:79]
    ds_read_b64_tr_b16 a[144:145], v15 offset:0
    v_permlane16_swap_b32 v52, v53
    v_max_f32 v52, v52, v53
    v_max3_f32 v60, v60, v61, v62
    v_max_f32 v60, v60, v63
    v_mfma_f32_16x16x32_bf16 v[76:79], a[112:115], a[224:227], v[76:79]
    ds_read_b64_tr_b16 a[146:147], v15 offset:4096
    v_sub_f32 v92, 0xc0e00000, v52
    v_sub_f32 v93, 0xc0e00000, v52
    v_mov_b32 v61, v60
    s_nop 0
    v_mfma_f32_16x16x32_bf16 v[84:87], a[100:103], a[228:231], 0
    ds_read_b64_tr_b16 a[148:149], v16 offset:0
    v_mov_b64 v[94:95], v[92:93]
    v_permlane32_swap_b32 v60, v61
    v_max_f32 v60, v60, v61
    v_mfma_f32_16x16x32_bf16 v[84:87], a[104:107], a[232:235], v[84:87]
    v_mov_b32 v61, v60
    s_nop 0
    v_mfma_f32_16x16x32_bf16 v[84:87], a[108:111], a[236:239], v[84:87]
    buffer_load_dwordx4 v4, s[12:15], s32 offen offset:0 nt lds
    v_permlane16_swap_b32 v60, v61
    v_max_f32 v60, v60, v61
    v_mfma_f32_16x16x32_bf16 v[84:87], a[112:115], a[240:243], v[84:87]
    v_sub_f32 v96, 0xc0e00000, v60
    v_sub_f32 v97, 0xc0e00000, v60
    v_max3_f32 v68, v68, v69, v70
    v_max_f32 v68, v68, v71
    v_mfma_f32_16x16x32_bf16 v[52:55], a[100:103], a[164:167], v[92:95]
    v_mov_b64 v[98:99], v[96:97]
    v_mov_b32 v69, v68
    s_nop 0
    v_mfma_f32_16x16x32_bf16 v[52:55], a[104:107], a[168:171], v[52:55]
    v_permlane32_swap_b32 v68, v69
    v_max_f32 v68, v68, v69
    v_mfma_f32_16x16x32_bf16 v[52:55], a[108:111], a[172:175], v[52:55]
    v_mov_b32 v69, v68
    s_nop 0
    v_max3_f32 v76, v76, v77, v78
    v_max_f32 v76, v76, v79
    v_mfma_f32_16x16x32_bf16 v[52:55], a[112:115], a[176:179], v[52:55]
    v_permlane16_swap_b32 v68, v69
    v_max_f32 v68, v68, v69
    v_mov_b32 v77, v76
    s_nop 0
    v_mfma_f32_16x16x32_bf16 v[56:59], a[116:119], a[164:167], v[92:95]
    v_sub_f32 v100, 0xc0e00000, v68
    v_sub_f32 v101, 0xc0e00000, v68
    v_permlane32_swap_b32 v76, v77
    v_max_f32 v76, v76, v77
    v_mfma_f32_16x16x32_bf16 v[56:59], a[120:123], a[168:171], v[56:59]
    v_mov_b64 v[102:103], v[100:101]
    v_mov_b32 v77, v76
    s_nop 0
    v_mfma_f32_16x16x32_bf16 v[56:59], a[124:127], a[172:175], v[56:59]
    v_permlane16_swap_b32 v76, v77
    v_max_f32 v76, v76, v77
    v_max3_f32 v84, v84, v85, v86
    v_max_f32 v84, v84, v87
    v_mfma_f32_16x16x32_bf16 v[56:59], a[128:131], a[176:179], v[56:59]
    v_sub_f32 v104, 0xc0e00000, v76
    v_sub_f32 v105, 0xc0e00000, v76
    v_mov_b32 v85, v84
    s_nop 0
    v_mfma_f32_16x16x32_bf16 v[60:63], a[100:103], a[180:183], v[96:99]
    v_mov_b64 v[106:107], v[104:105]
    v_permlane32_swap_b32 v84, v85
    v_max_f32 v84, v84, v85
    v_mfma_f32_16x16x32_bf16 v[60:63], a[104:107], a[184:187], v[60:63]
    v_mov_b32 v85, v84
    s_nop 0
    v_mfma_f32_16x16x32_bf16 v[60:63], a[108:111], a[188:191], v[60:63]
    v_permlane16_swap_b32 v84, v85
    v_max_f32 v84, v84, v85
    v_mfma_f32_16x16x32_bf16 v[60:63], a[112:115], a[192:195], v[60:63]
    v_sub_f32 v108, 0xc0e00000, v84
    v_sub_f32 v109, 0xc0e00000, v84
    v_mfma_f32_16x16x32_bf16 v[64:67], a[116:119], a[180:183], v[96:99]
    v_mov_b64 v[110:111], v[108:109]
    v_exp_f32 v24, v52
    v_exp_f32 v25, v53
    v_exp_f32 v26, v54
    v_mfma_f32_16x16x32_bf16 v[64:67], a[120:123], a[184:187], v[64:67]
    v_exp_f32 v27, v55
    v_exp_f32 v28, v56
    v_cvt_pk_bf16_f32 v32, v24, v25
    v_cvt_pk_bf16_f32 v33, v26, v27
    v_mfma_f32_16x16x32_bf16 v[64:67], a[124:127], a[188:191], v[64:67]
    v_exp_f32 v29, v57
    v_exp_f32 v30, v58
    v_exp_f32 v31, v59
    v_mfma_f32_16x16x32_bf16 v[64:67], a[128:131], a[192:195], v[64:67]
    v_cvt_pk_bf16_f32 v34, v28, v29
    v_or3_b32 v20, v32, v33, v34
    v_cvt_pk_bf16_f32 v35, v30, v31
    v_bitop3_b32 v20, v20, v35, s38 bitop3:0xa8
    v_cmp_ne_u32 vcc, 0, v20
L_loop:
    v_mfma_f32_16x16x32_bf16 v[68:71], a[100:103], a[196:199], v[100:103]
    ds_read_b64_tr_b16 a[150:151], v16 offset:4096
    v_add_u32 v12, s11, v12
    v_mfma_f32_16x16x32_bf16 v[68:71], a[104:107], a[200:203], v[68:71]
    ds_read_b64_tr_b16 a[152:153], v17 offset:0
    v_add_u32 v13, s11, v13
    v_mfma_f32_16x16x32_bf16 v[68:71], a[108:111], a[204:207], v[68:71]
    s_cbranch_vccnz L_slow0
L_back0:
    ds_read_b64_tr_b16 a[154:155], v17 offset:4096
    v_add_u32 v14, s11, v14
    v_mfma_f32_16x16x32_bf16 v[68:71], a[112:115], a[208:211], v[68:71]
    ds_read_b64_tr_b16 a[156:157], v18 offset:0
    v_add_u32 v15, s11, v15
    v_mfma_f32_16x16x32_bf16 v[72:75], a[116:119], a[196:199], v[100:103]
    ds_read_b64_tr_b16 a[158:159], v18 offset:4096
    v_add_u32 v16, s11, v16
    v_mfma_f32_16x16x32_bf16 v[72:75], a[120:123], a[200:203], v[72:75]
    ds_read_b64_tr_b16 a[160:161], v19 offset:0
    v_add_u32 v17, s11, v17
    v_mfma_f32_16x16x32_bf16 v[72:75], a[124:127], a[204:207], v[72:75]
    ds_read_b64_tr_b16 a[162:163], v19 offset:4096
    v_add_u32 v18, s11, v18
    v_mfma_f32_16x16x32_bf16 v[72:75], a[128:131], a[208:211], v[72:75]
    s_waitcnt lgkmcnt(8)
    v_exp_f32 v24, v60
    v_mfma_f32_16x16x32_bf16 v[112:115], a[132:135], v[32:35], v[112:115]
    buffer_load_dwordx4 v5, s[12:15], s32 offen offset:1024 nt lds
    v_mfma_f32_16x16x32_bf16 v[132:135], a[136:139], v[32:35], v[132:135]
    v_exp_f32 v25, v61
    v_mfma_f32_16x16x32_bf16 v[152:155], a[140:143], v[32:35], v[152:155]
    v_exp_f32 v26, v62
    v_mfma_f32_16x16x32_bf16 v[172:175], a[144:147], v[32:35], v[172:175]
    s_waitcnt lgkmcnt(4)
    v_exp_f32 v27, v63
    v_mfma_f32_16x16x32_bf16 a[0:3], a[148:151], v[32:35], a[0:3]
    v_exp_f32 v28, v64
    v_mfma_f32_16x16x32_bf16 a[20:23], a[152:155], v[32:35], a[20:23]
    s_waitcnt lgkmcnt(0)
    v_exp_f32 v29, v65
    v_mfma_f32_16x16x32_bf16 a[40:43], a[156:159], v[32:35], a[40:43]
    v_exp_f32 v30, v66
    v_mfma_f32_16x16x32_bf16 a[60:63], a[160:163], v[32:35], a[60:63]
    v_exp_f32 v31, v67
    v_mfma_f32_16x16x32_bf16 a[80:83], a[244:247], v[32:35], a[80:83]
    v_cvt_pk_bf16_f32 v36, v24, v25
    v_cvt_pk_bf16_f32 v37, v26, v27
    v_mfma_f32_16x16x32_bf16 v[76:79], a[100:103], a[212:215], v[104:107]
    v_cvt_pk_bf16_f32 v38, v28, v29
    v_cvt_pk_bf16_f32 v39, v30, v31
    v_mfma_f32_16x16x32_bf16 v[76:79], a[104:107], a[216:219], v[76:79]
    v_or3_b32 v20, v36, v37, v38
    v_add_u32 v19, s11, v19
    v_mfma_f32_16x16x32_bf16 v[76:79], a[108:111], a[220:223], v[76:79]
    v_bitop3_b32 v20, v20, v39, s38 bitop3:0xa8
    v_cmp_ne_u32 vcc, 0, v20
    v_mfma_f32_16x16x32_bf16 v[76:79], a[112:115], a[224:227], v[76:79]
    buffer_load_dwordx4 v6, s[12:15], s32 offen offset:2048 nt lds
    v_mfma_f32_16x16x32_bf16 v[80:83], a[116:119], a[212:215], v[104:107]
    v_exp_f32 v204, v68
    v_mfma_f32_16x16x32_bf16 v[80:83], a[120:123], a[216:219], v[80:83]
    v_exp_f32 v205, v69
    v_mfma_f32_16x16x32_bf16 v[80:83], a[124:127], a[220:223], v[80:83]
    s_cbranch_vccnz L_slow1
L_back1:
    v_exp_f32 v206, v70
    v_mfma_f32_16x16x32_bf16 v[80:83], a[128:131], a[224:227], v[80:83]
    v_exp_f32 v207, v71
    v_mfma_f32_16x16x32_bf16 v[116:119], a[132:135], v[36:39], v[116:119]
    v_exp_f32 v208, v72
    v_mfma_f32_16x16x32_bf16 v[136:139], a[136:139], v[36:39], v[136:139]
    v_exp_f32 v209, v73
    v_mfma_f32_16x16x32_bf16 v[156:159], a[140:143], v[36:39], v[156:159]
    v_exp_f32 v210, v74
    v_mfma_f32_16x16x32_bf16 v[176:179], a[144:147], v[36:39], v[176:179]
    v_exp_f32 v211, v75
    v_mfma_f32_16x16x32_bf16 a[4:7], a[148:151], v[36:39], a[4:7]
    v_cvt_pk_bf16_f32 v40, v204, v205
    v_cvt_pk_bf16_f32 v41, v206, v207
    v_mfma_f32_16x16x32_bf16 a[24:27], a[152:155], v[36:39], a[24:27]
    buffer_load_dwordx4 v7, s[12:15], s32 offen offset:3072 nt lds
    v_mfma_f32_16x16x32_bf16 a[44:47], a[156:159], v[36:39], a[44:47]
    v_exp_f32 v24, v76
    v_mfma_f32_16x16x32_bf16 a[64:67], a[160:163], v[36:39], a[64:67]
    v_exp_f32 v25, v77
    v_mfma_f32_16x16x32_bf16 a[84:87], a[244:247], v[36:39], a[84:87]
    v_cvt_pk_bf16_f32 v42, v208, v209
    v_cvt_pk_bf16_f32 v43, v210, v211
    v_add_u32 v11, s11, v11
    s_cmp_eq_u32 s44, 131072
    s_cselect_b32 s11, s36, 32768
    s_add_u32 s44, s44, s11
    s_cmp_eq_u32 s43, 131072
    s_cselect_b32 s59, s36, 32768
    s_add_u32 s43, s43, s59
    s_add_u32 s45, s45, s59
    s_cmp_ge_u32 s34, 13
    s_cbranch_scc1 L_special
L_bar:
    s_waitcnt vmcnt(4)
    s_barrier
    v_mfma_f32_16x16x32_bf16 v[84:87], a[100:103], a[228:231], v[108:111]
    ds_read_b128 a[100:103], v8 offset:0
    v_or3_b32 v21, v40, v41, v42
    v_mfma_f32_16x16x32_bf16 v[84:87], a[104:107], a[232:235], v[84:87]
    ds_read_b128 a[104:107], v9 offset:0
    v_bitop3_b32 v21, v21, v43, s38 bitop3:0xa8
    v_mfma_f32_16x16x32_bf16 v[84:87], a[108:111], a[236:239], v[84:87]
    ds_read_b128 a[108:111], v10 offset:0
    v_cmp_ne_u32 vcc, 0, v21
    v_mfma_f32_16x16x32_bf16 v[84:87], a[112:115], a[240:243], v[84:87]
    ds_read_b128 a[112:115], v11 offset:0
    v_cvt_pk_bf16_f32 v44, v24, v25
    v_mfma_f32_16x16x32_bf16 v[88:91], a[116:119], a[228:231], v[108:111]
    v_exp_f32 v26, v78
    v_mfma_f32_16x16x32_bf16 v[88:91], a[120:123], a[232:235], v[88:91]
    s_add_u32 s10, s32, 4096
    v_exp_f32 v27, v79
    v_mfma_f32_16x16x32_bf16 v[88:91], a[124:127], a[236:239], v[88:91]
    s_cbranch_vccnz L_slow2
L_back2:
    v_exp_f32 v28, v80
    v_mfma_f32_16x16x32_bf16 v[88:91], a[128:131], a[240:243], v[88:91]
    s_add_u32 m0, m0, 4096
    v_exp_f32 v29, v81
    v_mfma_f32_16x16x32_bf16 v[120:123], a[132:135], v[40:43], v[120:123]
    buffer_load_dwordx4 v246, s[12:15], s10 offen offset:0 nt lds
    v_mfma_f32_16x16x32_bf16 v[140:143], a[136:139], v[40:43], v[140:143]
    v_exp_f32 v30, v82
    v_mfma_f32_16x16x32_bf16 v[160:163], a[140:143], v[40:43], v[160:163]
    v_exp_f32 v31, v83
    v_mfma_f32_16x16x32_bf16 v[180:183], a[144:147], v[40:43], v[180:183]
    ds_read_b128 a[116:119], v8 offset:4096
    v_cvt_pk_bf16_f32 v45, v26, v27
    v_mfma_f32_16x16x32_bf16 a[8:11], a[148:151], v[40:43], a[8:11]
    ds_read_b128 a[120:123], v9 offset:4096
    v_cvt_pk_bf16_f32 v46, v28, v29
    v_mfma_f32_16x16x32_bf16 a[28:31], a[152:155], v[40:43], a[28:31]
    ds_read_b128 a[124:127], v10 offset:4096
    v_cvt_pk_bf16_f32 v47, v30, v31
    v_mfma_f32_16x16x32_bf16 a[48:51], a[156:159], v[40:43], a[48:51]
    ds_read_b128 a[128:131], v11 offset:4096
    v_or3_b32 v20, v44, v45, v46
    v_mfma_f32_16x16x32_bf16 a[68:71], a[160:163], v[40:43], a[68:71]
    v_bitop3_b32 v20, v20, v47, s38 bitop3:0xa8
    v_cmp_ne_u32 vcc, 0, v20
    v_mfma_f32_16x16x32_bf16 a[88:91], a[244:247], v[40:43], a[88:91]
    s_waitcnt lgkmcnt(4)
    v_exp_f32 v204, v84
    v_mfma_f32_16x16x32_bf16 v[52:55], a[100:103], a[164:167], v[92:95]
    buffer_load_dwordx4 v247, s[12:15], s10 offen offset:1024 nt lds
    v_mfma_f32_16x16x32_bf16 v[52:55], a[104:107], a[168:171], v[52:55]
    v_exp_f32 v205, v85
    v_mfma_f32_16x16x32_bf16 v[52:55], a[108:111], a[172:175], v[52:55]
    s_cbranch_vccnz L_slow3
L_back3:
    v_mfma_f32_16x16x32_bf16 v[52:55], a[112:115], a[176:179], v[52:55]
    s_waitcnt lgkmcnt(0)
    v_exp_f32 v206, v86
    v_mfma_f32_16x16x32_bf16 v[56:59], a[116:119], a[164:167], v[92:95]
    v_exp_f32 v207, v87
    v_mfma_f32_16x16x32_bf16 v[56:59], a[120:123], a[168:171], v[56:59]
    v_exp_f32 v208, v88
    v_mfma_f32_16x16x32_bf16 v[56:59], a[124:127], a[172:175], v[56:59]
    v_exp_f32 v209, v89
    v_mfma_f32_16x16x32_bf16 v[56:59], a[128:131], a[176:179], v[56:59]
    v_exp_f32 v210, v90
    v_mfma_f32_16x16x32_bf16 v[124:127], a[132:135], v[44:47], v[124:127]
    v_exp_f32 v211, v91
    v_mfma_f32_16x16x32_bf16 v[144:147], a[136:139], v[44:47], v[144:147]
    buffer_load_dwordx4 v248, s[12:15], s10 offen offset:2048 nt lds
    v_mfma_f32_16x16x32_bf16 v[164:167], a[140:143], v[44:47], v[164:167]
    v_cvt_pk_bf16_f32 v48, v204, v205
    v_cvt_pk_bf16_f32 v49, v206, v207
    v_mfma_f32_16x16x32_bf16 v[184:187], a[144:147], v[44:47], v[184:187]
    v_cvt_pk_bf16_f32 v50, v208, v209
    v_cvt_pk_bf16_f32 v51, v210, v211
    v_mfma_f32_16x16x32_bf16 a[12:15], a[148:151], v[44:47], a[12:15]
    v_or3_b32 v21, v48, v49, v50
    v_add_u32 v8, s11, v8
    v_mfma_f32_16x16x32_bf16 a[32:35], a[152:155], v[44:47], a[32:35]
    v_exp_f32 v24, v52
    v_mfma_f32_16x16x32_bf16 a[52:55], a[156:159], v[44:47], a[52:55]
    v_bitop3_b32 v21, v21, v51, s38 bitop3:0xa8
    v_cmp_ne_u32 vcc, 0, v21
    v_mfma_f32_16x16x32_bf16 a[72:75], a[160:163], v[44:47], a[72:75]
    v_exp_f32 v25, v53
    v_mfma_f32_16x16x32_bf16 a[92:95], a[244:247], v[44:47], a[92:95]
    v_exp_f32 v26, v54
    v_mfma_f32_16x16x32_bf16 v[60:63], a[100:103], a[180:183], v[96:99]
    buffer_load_dwordx4 v249, s[12:15], s10 offen offset:3072 nt lds
    v_mfma_f32_16x16x32_bf16 v[60:63], a[104:107], a[184:187], v[60:63]
    v_exp_f32 v27, v55
    v_mfma_f32_16x16x32_bf16 v[60:63], a[108:111], a[188:191], v[60:63]
    v_exp_f32 v28, v56
    v_mfma_f32_16x16x32_bf16 v[60:63], a[112:115], a[192:195], v[60:63]
    s_add_u32 s32, s32, s37
    v_exp_f32 v29, v57
    v_mfma_f32_16x16x32_bf16 v[64:67], a[116:119], a[180:183], v[96:99]
    s_mov_b32 m0, s45
    v_exp_f32 v30, v58
    v_mfma_f32_16x16x32_bf16 v[64:67], a[120:123], a[184:187], v[64:67]
    s_add_u32 s34, s34, 1
    v_exp_f32 v31, v59
    v_mfma_f32_16x16x32_bf16 v[64:67], a[124:127], a[188:191], v[64:67]
    s_cbranch_vccnz L_slow4
L_back4:
    v_mfma_f32_16x16x32_bf16 v[64:67], a[128:131], a[192:195], v[64:67]
    buffer_load_dwordx4 v4, s[12:15], s32 offen offset:0 nt lds
    v_mfma_f32_16x16x32_bf16 v[128:131], a[132:135], v[48:51], v[128:131]
    ds_read_b64_tr_b16 a[132:133], v12 offset:0
    v_cvt_pk_bf16_f32 v32, v24, v25
    v_mfma_f32_16x16x32_bf16 v[148:151], a[136:139], v[48:51], v[148:151]
    ds_read_b64_tr_b16 a[134:135], v12 offset:4096
    v_cvt_pk_bf16_f32 v33, v26, v27
    v_mfma_f32_16x16x32_bf16 v[168:171], a[140:143], v[48:51], v[168:171]
    ds_read_b64_tr_b16 a[136:137], v13 offset:0
    v_cvt_pk_bf16_f32 v34, v28, v29
    v_mfma_f32_16x16x32_bf16 v[188:191], a[144:147], v[48:51], v[188:191]
    ds_read_b64_tr_b16 a[138:139], v13 offset:4096
    v_cvt_pk_bf16_f32 v35, v30, v31
    v_mfma_f32_16x16x32_bf16 a[16:19], a[148:151], v[48:51], a[16:19]
    ds_read_b64_tr_b16 a[140:141], v14 offset:0
    v_or3_b32 v20, v32, v33, v34
    v_mfma_f32_16x16x32_bf16 a[36:39], a[152:155], v[48:51], a[36:39]
    ds_read_b64_tr_b16 a[142:143], v14 offset:4096
    v_bitop3_b32 v20, v20, v35, s38 bitop3:0xa8
    v_mfma_f32_16x16x32_bf16 a[56:59], a[156:159], v[48:51], a[56:59]
    ds_read_b64_tr_b16 a[144:145], v15 offset:0
    v_cmp_ne_u32 vcc, 0, v20
    v_mfma_f32_16x16x32_bf16 a[76:79], a[160:163], v[48:51], a[76:79]
    ds_read_b64_tr_b16 a[146:147], v15 offset:4096
    v_add_u32 v9, s11, v9
    v_mfma_f32_16x16x32_bf16 a[96:99], a[244:247], v[48:51], a[96:99]
    ds_read_b64_tr_b16 a[148:149], v16 offset:0
    v_add_u32 v10, s11, v10
    s_branch L_loop
L_special:
    s_cmp_eq_u32 s34, 15
    s_cbranch_scc1 L_last
    v_mov_b32 v4, 0
    v_mov_b32 v5, 0
    v_mov_b32 v6, 0
    v_mov_b32 v7, 0
    s_mov_b32 s37, 0
    s_cmp_eq_u32 s34, 13
    s_cbranch_scc1 L_bar
    v_mov_b32 v246, 0
    v_mov_b32 v247, 0
    v_mov_b32 v248, 0
    v_mov_b32 v249, 0
    s_branch L_bar
L_last:
    s_barrier
    s_lshl_b32 s9, s48, 7
    s_add_u32 s9, s9, s35
    s_lshl_b32 s10, s49, 7
    s_add_u32 s10, s10, s35
    s_mov_b32 m0, s33
    v_mov_b32 v4, v23
    v_add_u32 v5, 0x2000, v23
    v_add_u32 v6, 0x4000, v23
    v_add_u32 v7, 0x6000, v23
    buffer_load_dwordx4 v4, s[24:27], s9 offen offset:0  lds
    buffer_load_dwordx4 v5, s[24:27], s9 offen offset:1024  lds
    buffer_load_dwordx4 v6, s[24:27], s9 offen offset:2048  lds
    buffer_load_dwordx4 v7, s[24:27], s9 offen offset:3072  lds
    v_mfma_f32_16x16x32_bf16 v[84:87], a[100:103], a[228:231], v[108:111]
    ds_write_b128 v192, a[0:3] offset:0
    v_or3_b32 v21, v40, v41, v42
    v_mfma_f32_16x16x32_bf16 v[84:87], a[104:107], a[232:235], v[84:87]
    ds_write_b32 v196, v92 offset:10240
    v_bitop3_b32 v21, v21, v43, s38 bitop3:0xa8
    v_mfma_f32_16x16x32_bf16 v[84:87], a[108:111], a[236:239], v[84:87]
    ds_write_b32 v196, a80 offset:11520
    v_cmp_ne_u32 vcc, 0, v21
    v_mfma_f32_16x16x32_bf16 v[84:87], a[112:115], a[240:243], v[84:87]
    ds_write_b128 v192, a[20:23] offset:1024
    v_exp_f32 v26, v78
    v_mfma_f32_16x16x32_bf16 v[88:91], a[116:119], a[228:231], v[108:111]
    s_add_u32 m0, s33, 4096
    v_exp_f32 v27, v79
    v_mfma_f32_16x16x32_bf16 v[88:91], a[120:123], a[232:235], v[88:91]
    s_add_u32 s9, s9, 36864
    v_exp_f32 v28, v80
    v_mfma_f32_16x16x32_bf16 v[88:91], a[124:127], a[236:239], v[88:91]
    s_cbranch_vccnz L_slow5
L_back5:
    ds_write_b128 v192, a[40:43] offset:2048
    v_exp_f32 v29, v81
    v_mfma_f32_16x16x32_bf16 v[88:91], a[128:131], a[240:243], v[88:91]
    buffer_load_dwordx4 v4, s[24:27], s9 offen offset:0  lds
    v_exp_f32 v30, v82
    v_mfma_f32_16x16x32_bf16 v[120:123], a[132:135], v[40:43], v[120:123]
    buffer_load_dwordx4 v5, s[24:27], s9 offen offset:1024  lds
    v_exp_f32 v31, v83
    v_mfma_f32_16x16x32_bf16 v[140:143], a[136:139], v[40:43], v[140:143]
    ds_write_b128 v192, a[60:63] offset:3072
    v_cvt_pk_bf16_f32 v44, v24, v25
    v_mfma_f32_16x16x32_bf16 v[160:163], a[140:143], v[40:43], v[160:163]
    buffer_load_dwordx4 v6, s[24:27], s9 offen offset:2048  lds
    v_cvt_pk_bf16_f32 v45, v26, v27
    v_mfma_f32_16x16x32_bf16 v[180:183], a[144:147], v[40:43], v[180:183]
    buffer_load_dwordx4 v7, s[24:27], s9 offen offset:3072  lds
    v_cvt_pk_bf16_f32 v46, v28, v29
    v_mfma_f32_16x16x32_bf16 a[8:11], a[148:151], v[40:43], a[8:11]
    ds_write_b128 v192, a[4:7] offset:4096
    v_cvt_pk_bf16_f32 v47, v30, v31
    v_mfma_f32_16x16x32_bf16 a[28:31], a[152:155], v[40:43], a[28:31]
    s_add_u32 m0, s33, 32768
    v_or3_b32 v20, v44, v45, v46
    v_bitop3_b32 v20, v20, v47, s38 bitop3:0xa8
    v_mfma_f32_16x16x32_bf16 a[48:51], a[156:159], v[40:43], a[48:51]
    ds_write_b32 v196, v96 offset:10496
    v_cmp_ne_u32 vcc, 0, v20
    v_mfma_f32_16x16x32_bf16 a[68:71], a[160:163], v[40:43], a[68:71]
    ds_write_b128 v192, a[24:27] offset:5120
    v_exp_f32 v204, v84
    v_mfma_f32_16x16x32_bf16 a[88:91], a[244:247], v[40:43], a[88:91]
    s_cbranch_vccnz L_slow6
L_back6:
    v_exp_f32 v205, v85
    v_mfma_f32_16x16x32_bf16 v[124:127], a[132:135], v[44:47], v[124:127]
    buffer_load_dwordx4 v4, s[24:27], s10 offen offset:0  lds
    v_exp_f32 v206, v86
    v_mfma_f32_16x16x32_bf16 v[144:147], a[136:139], v[44:47], v[144:147]
    ds_write_b128 v192, a[44:47] offset:6144
    v_exp_f32 v207, v87
    v_mfma_f32_16x16x32_bf16 v[164:167], a[140:143], v[44:47], v[164:167]
    buffer_load_dwordx4 v5, s[24:27], s10 offen offset:1024  lds
    v_exp_f32 v208, v88
    v_mfma_f32_16x16x32_bf16 v[184:187], a[144:147], v[44:47], v[184:187]
    buffer_load_dwordx4 v6, s[24:27], s10 offen offset:2048  lds
    v_exp_f32 v209, v89
    v_mfma_f32_16x16x32_bf16 a[12:15], a[148:151], v[44:47], a[12:15]
    ds_write_b128 v192, a[64:67] offset:7168
    v_exp_f32 v210, v90
    v_mfma_f32_16x16x32_bf16 a[32:35], a[152:155], v[44:47], a[32:35]
    buffer_load_dwordx4 v7, s[24:27], s10 offen offset:3072  lds
    v_exp_f32 v211, v91
    v_mfma_f32_16x16x32_bf16 a[52:55], a[156:159], v[44:47], a[52:55]
    s_add_u32 m0, s33, 36864
    v_cvt_pk_bf16_f32 v48, v204, v205
    v_cvt_pk_bf16_f32 v49, v206, v207
    v_mfma_f32_16x16x32_bf16 a[72:75], a[160:163], v[44:47], a[72:75]
    ds_write_b128 v192, a[8:11] offset:8192
    v_cvt_pk_bf16_f32 v50, v208, v209
    v_cvt_pk_bf16_f32 v51, v210, v211
    v_mfma_f32_16x16x32_bf16 a[92:95], a[244:247], v[44:47], a[92:95]
    v_or3_b32 v21, v48, v49, v50
    v_bitop3_b32 v21, v21, v51, s38 bitop3:0xa8
    v_cmp_ne_u32 vcc, 0, v21
    s_add_u32 s10, s10, 36864
    s_nop 0
    s_nop 0
    s_cbranch_vccnz L_slow7
L_back7:
    v_mfma_f32_16x16x32_bf16 v[128:131], a[132:135], v[48:51], v[128:131]
    ds_write_b32 v196, a84 offset:11776
    v_mfma_f32_16x16x32_bf16 v[148:151], a[136:139], v[48:51], v[148:151]
    ds_write_b128 v192, a[28:31] offset:9216
    v_mfma_f32_16x16x32_bf16 v[168:171], a[140:143], v[48:51], v[168:171]
    buffer_load_dwordx4 v4, s[24:27], s10 offen offset:0  lds
    v_mfma_f32_16x16x32_bf16 v[188:191], a[144:147], v[48:51], v[188:191]
    buffer_load_dwordx4 v5, s[24:27], s10 offen offset:1024  lds
    v_mfma_f32_16x16x32_bf16 a[16:19], a[148:151], v[48:51], a[16:19]
    ds_write_b128 v194, a[48:51] offset:0
    v_mfma_f32_16x16x32_bf16 a[36:39], a[152:155], v[48:51], a[36:39]
    buffer_load_dwordx4 v6, s[24:27], s10 offen offset:2048  lds
    v_mfma_f32_16x16x32_bf16 a[56:59], a[156:159], v[48:51], a[56:59]
    buffer_load_dwordx4 v7, s[24:27], s10 offen offset:3072  lds
    v_mfma_f32_16x16x32_bf16 a[76:79], a[160:163], v[48:51], a[76:79]
    ds_write_b128 v194, a[68:71] offset:1024
    v_mfma_f32_16x16x32_bf16 a[96:99], a[244:247], v[48:51], a[96:99]
    ds_write_b32 v196, v100 offset:10752
    ds_write_b32 v196, a88 offset:12032
    ds_write_b128 v194, a[12:15] offset:2048
    ds_write_b128 v194, a[32:35] offset:3072
    ds_write_b128 v194, a[52:55] offset:4096
    ds_write_b128 v194, a[72:75] offset:5120
    ds_write_b32 v196, v104 offset:11008
    ds_write_b32 v196, a92 offset:12288
    v_accvgpr_read_b32 v93, a80
    v_accvgpr_read_b32 v97, a84
    v_accvgpr_read_b32 v101, a88
    v_accvgpr_read_b32 v105, a92
    ds_write_b32 v196, v108 offset:11264
    ds_write_b32 v196, a96 offset:12544
    ds_write_b128 v194, a[16:19] offset:6144
    ds_write_b128 v194, a[36:39] offset:7168
    ds_write_b128 v194, a[56:59] offset:8192
    ds_write_b128 v194, a[76:79] offset:9216
    v_accvgpr_read_b32 v109, a96
    v_lshrrev_b32 v26, 2, v2
    v_and_b32 v27, 1, v3
    v_lshl_add_u32 v26, v27, 2, v26
    v_lshrrev_b32 v27, 1, v26
    v_xor_b32 v27, s6, v27
    v_lshlrev_b32 v25, 7, v26
    v_lshl_add_u32 v25, v27, 5, v25
    v_and_b32 v27, 3, v2
    v_lshl_add_u32 v25, v27, 3, v25
    v_lshrrev_b32 v27, 1, v3
    v_lshl_add_u32 v25, v27, 10, v25
    v_add_u32 v26, 0x10000, v25
    v_add_u32 v27, 0x20000, v25
    s_waitcnt lgkmcnt(0)
    s_barrier
    ds_read_b32 v52, v197 offset:10240
    ds_read_b32 v57, v197 offset:11520
    ds_read_b32 v53, v197 offset:10496
    ds_read_b32 v58, v197 offset:11776
    ds_read_b32 v54, v197 offset:10752
    ds_read_b32 v59, v197 offset:12032
    ds_read_b32 v55, v197 offset:11008
    ds_read_b32 v60, v197 offset:12288
    ds_read_b32 v56, v197 offset:11264
    ds_read_b32 v61, v197 offset:12544
    ds_read_b128 v[200:203], v193 offset:0
    ds_read_b128 v[204:207], v193 offset:1024
    ds_read_b128 v[208:211], v193 offset:2048
    ds_read_b128 v[212:215], v193 offset:3072
    ds_read_b128 v[216:219], v193 offset:4096
    ds_read_b128 v[220:223], v193 offset:5120
    ds_read_b128 v[224:227], v193 offset:6144
    ds_read_b128 v[228:231], v193 offset:7168
    ds_read_b128 v[232:235], v193 offset:8192
    ds_read_b128 v[236:239], v193 offset:9216
    ds_read_b128 v[240:243], v195 offset:0
    ds_read_b128 v[244:247], v195 offset:1024
    ds_read_b128 v[248:251], v195 offset:2048
    ds_read_b128 v[252:255], v195 offset:3072
    s_waitcnt lgkmcnt(14)
    v_min_f32 v94, v92, v52
    v_min_f32 v98, v96, v53
    v_min_f32 v102, v100, v54
    v_min_f32 v106, v104, v55
    v_min_f32 v110, v108, v56
    v_sub_f32 v92, v94, v92
    v_sub_f32 v52, v94, v52
    v_sub_f32 v96, v98, v96
    v_sub_f32 v53, v98, v53
    v_sub_f32 v100, v102, v100
    v_sub_f32 v54, v102, v54
    v_sub_f32 v104, v106, v104
    v_sub_f32 v55, v106, v55
    v_sub_f32 v108, v110, v108
    v_sub_f32 v56, v110, v56
    ds_read_b128 v[32:35], v195 offset:4096
    ds_read_b128 v[36:39], v195 offset:5120
    ds_read_b128 v[40:43], v195 offset:6144
    ds_read_b128 v[44:47], v195 offset:7168
    ds_read_b128 v[48:51], v195 offset:8192
    ds_read_b128 v[62:65], v195 offset:9216
    v_exp_f32 v92, v92
    v_exp_f32 v52, v52
    v_exp_f32 v96, v96
    v_exp_f32 v53, v53
    v_exp_f32 v100, v100
    v_exp_f32 v54, v54
    v_exp_f32 v104, v104
    v_exp_f32 v55, v55
    v_exp_f32 v108, v108
    v_exp_f32 v56, v56
    v_mul_f32 v93, v92, v93
    v_mul_f32 v97, v96, v97
    v_mul_f32 v101, v100, v101
    v_mul_f32 v105, v104, v105
    v_mul_f32 v109, v108, v109
    v_fmac_f32 v93, v52, v57
    v_fmac_f32 v97, v53, v58
    v_fmac_f32 v101, v54, v59
    v_fmac_f32 v105, v55, v60
    v_fmac_f32 v109, v56, v61
    v_rcp_f32 v93, v93
    v_rcp_f32 v97, v97
    v_rcp_f32 v101, v101
    v_rcp_f32 v105, v105
    v_rcp_f32 v109, v109
    v_mul_f32 v66, v92, v93
    v_mul_f32 v76, v52, v93
    v_mul_f32 v68, v96, v97
    v_mul_f32 v78, v53, v97
    v_mul_f32 v70, v100, v101
    v_mul_f32 v80, v54, v101
    v_mul_f32 v72, v104, v105
    v_mul_f32 v82, v55, v105
    v_mul_f32 v74, v108, v109
    v_mul_f32 v84, v56, v109
    s_waitcnt lgkmcnt(0)
    v_pk_mul_f32 v[112:113], v[112:113], v[66:67] op_sel_hi:[1,0]
    v_pk_mul_f32 v[114:115], v[114:115], v[66:67] op_sel_hi:[1,0]
    v_pk_mul_f32 v[132:133], v[132:133], v[66:67] op_sel_hi:[1,0]
    v_pk_mul_f32 v[134:135], v[134:135], v[66:67] op_sel_hi:[1,0]
    v_pk_mul_f32 v[152:153], v[152:153], v[66:67] op_sel_hi:[1,0]
    v_pk_mul_f32 v[154:155], v[154:155], v[66:67] op_sel_hi:[1,0]
    v_pk_mul_f32 v[172:173], v[172:173], v[66:67] op_sel_hi:[1,0]
    v_pk_mul_f32 v[174:175], v[174:175], v[66:67] op_sel_hi:[1,0]
    v_pk_fma_f32 v[112:113], v[200:201], v[76:77], v[112:113] op_sel_hi:[1,0,1]
    v_pk_fma_f32 v[114:115], v[202:203], v[76:77], v[114:115] op_sel_hi:[1,0,1]
    v_pk_fma_f32 v[132:133], v[204:205], v[76:77], v[132:133] op_sel_hi:[1,0,1]
    v_pk_fma_f32 v[134:135], v[206:207], v[76:77], v[134:135] op_sel_hi:[1,0,1]
    v_pk_fma_f32 v[152:153], v[208:209], v[76:77], v[152:153] op_sel_hi:[1,0,1]
    v_pk_fma_f32 v[154:155], v[210:211], v[76:77], v[154:155] op_sel_hi:[1,0,1]
    v_pk_fma_f32 v[172:173], v[212:213], v[76:77], v[172:173] op_sel_hi:[1,0,1]
    v_pk_fma_f32 v[174:175], v[214:215], v[76:77], v[174:175] op_sel_hi:[1,0,1]
    v_cvt_pk_bf16_f32 v92, v112, v113
    v_cvt_pk_bf16_f32 v93, v114, v115
    v_cvt_pk_bf16_f32 v94, v132, v133
    v_cvt_pk_bf16_f32 v95, v134, v135
    v_cvt_pk_bf16_f32 v96, v152, v153
    v_cvt_pk_bf16_f32 v97, v154, v155
    v_cvt_pk_bf16_f32 v98, v172, v173
    v_cvt_pk_bf16_f32 v99, v174, v175
    ds_write_b128 v193, v[92:95] offset:0
    ds_write_b128 v193, v[96:99] offset:5120
    v_pk_mul_f32 v[116:117], v[116:117], v[68:69] op_sel_hi:[1,0]
    v_pk_mul_f32 v[118:119], v[118:119], v[68:69] op_sel_hi:[1,0]
    v_pk_mul_f32 v[136:137], v[136:137], v[68:69] op_sel_hi:[1,0]
    v_pk_mul_f32 v[138:139], v[138:139], v[68:69] op_sel_hi:[1,0]
    v_pk_mul_f32 v[156:157], v[156:157], v[68:69] op_sel_hi:[1,0]
    v_pk_mul_f32 v[158:159], v[158:159], v[68:69] op_sel_hi:[1,0]
    v_pk_mul_f32 v[176:177], v[176:177], v[68:69] op_sel_hi:[1,0]
    v_pk_mul_f32 v[178:179], v[178:179], v[68:69] op_sel_hi:[1,0]
    v_pk_fma_f32 v[116:117], v[216:217], v[78:79], v[116:117] op_sel_hi:[1,0,1]
    v_pk_fma_f32 v[118:119], v[218:219], v[78:79], v[118:119] op_sel_hi:[1,0,1]
    v_pk_fma_f32 v[136:137], v[220:221], v[78:79], v[136:137] op_sel_hi:[1,0,1]
    v_pk_fma_f32 v[138:139], v[222:223], v[78:79], v[138:139] op_sel_hi:[1,0,1]
    v_pk_fma_f32 v[156:157], v[224:225], v[78:79], v[156:157] op_sel_hi:[1,0,1]
    v_pk_fma_f32 v[158:159], v[226:227], v[78:79], v[158:159] op_sel_hi:[1,0,1]
    v_pk_fma_f32 v[176:177], v[228:229], v[78:79], v[176:177] op_sel_hi:[1,0,1]
    v_pk_fma_f32 v[178:179], v[230:231], v[78:79], v[178:179] op_sel_hi:[1,0,1]
    v_cvt_pk_bf16_f32 v100, v116, v117
    v_cvt_pk_bf16_f32 v101, v118, v119
    v_cvt_pk_bf16_f32 v102, v136, v137
    v_cvt_pk_bf16_f32 v103, v138, v139
    v_cvt_pk_bf16_f32 v104, v156, v157
    v_cvt_pk_bf16_f32 v105, v158, v159
    v_cvt_pk_bf16_f32 v106, v176, v177
    v_cvt_pk_bf16_f32 v107, v178, v179
    ds_write_b128 v193, v[100:103] offset:1024
    ds_write_b128 v193, v[104:107] offset:6144
    v_pk_mul_f32 v[120:121], v[120:121], v[70:71] op_sel_hi:[1,0]
    v_pk_mul_f32 v[122:123], v[122:123], v[70:71] op_sel_hi:[1,0]
    v_pk_mul_f32 v[140:141], v[140:141], v[70:71] op_sel_hi:[1,0]
    v_pk_mul_f32 v[142:143], v[142:143], v[70:71] op_sel_hi:[1,0]
    v_pk_mul_f32 v[160:161], v[160:161], v[70:71] op_sel_hi:[1,0]
    v_pk_mul_f32 v[162:163], v[162:163], v[70:71] op_sel_hi:[1,0]
    v_pk_mul_f32 v[180:181], v[180:181], v[70:71] op_sel_hi:[1,0]
    v_pk_mul_f32 v[182:183], v[182:183], v[70:71] op_sel_hi:[1,0]
    v_pk_fma_f32 v[120:121], v[232:233], v[80:81], v[120:121] op_sel_hi:[1,0,1]
    v_pk_fma_f32 v[122:123], v[234:235], v[80:81], v[122:123] op_sel_hi:[1,0,1]
    v_pk_fma_f32 v[140:141], v[236:237], v[80:81], v[140:141] op_sel_hi:[1,0,1]
    v_pk_fma_f32 v[142:143], v[238:239], v[80:81], v[142:143] op_sel_hi:[1,0,1]
    v_pk_fma_f32 v[160:161], v[240:241], v[80:81], v[160:161] op_sel_hi:[1,0,1]
    v_pk_fma_f32 v[162:163], v[242:243], v[80:81], v[162:163] op_sel_hi:[1,0,1]
    v_pk_fma_f32 v[180:181], v[244:245], v[80:81], v[180:181] op_sel_hi:[1,0,1]
    v_pk_fma_f32 v[182:183], v[246:247], v[80:81], v[182:183] op_sel_hi:[1,0,1]
    v_cvt_pk_bf16_f32 v92, v120, v121
    v_cvt_pk_bf16_f32 v93, v122, v123
    v_cvt_pk_bf16_f32 v94, v140, v141
    v_cvt_pk_bf16_f32 v95, v142, v143
    v_cvt_pk_bf16_f32 v96, v160, v161
    v_cvt_pk_bf16_f32 v97, v162, v163
    v_cvt_pk_bf16_f32 v98, v180, v181
    v_cvt_pk_bf16_f32 v99, v182, v183
    ds_write_b128 v193, v[92:95] offset:2048
    ds_write_b128 v193, v[96:99] offset:7168
    v_pk_mul_f32 v[124:125], v[124:125], v[72:73] op_sel_hi:[1,0]
    v_pk_mul_f32 v[126:127], v[126:127], v[72:73] op_sel_hi:[1,0]
    v_pk_mul_f32 v[144:145], v[144:145], v[72:73] op_sel_hi:[1,0]
    v_pk_mul_f32 v[146:147], v[146:147], v[72:73] op_sel_hi:[1,0]
    v_pk_mul_f32 v[164:165], v[164:165], v[72:73] op_sel_hi:[1,0]
    v_pk_mul_f32 v[166:167], v[166:167], v[72:73] op_sel_hi:[1,0]
    v_pk_mul_f32 v[184:185], v[184:185], v[72:73] op_sel_hi:[1,0]
    v_pk_mul_f32 v[186:187], v[186:187], v[72:73] op_sel_hi:[1,0]
    v_pk_fma_f32 v[124:125], v[248:249], v[82:83], v[124:125] op_sel_hi:[1,0,1]
    v_pk_fma_f32 v[126:127], v[250:251], v[82:83], v[126:127] op_sel_hi:[1,0,1]
    v_pk_fma_f32 v[144:145], v[252:253], v[82:83], v[144:145] op_sel_hi:[1,0,1]
    v_pk_fma_f32 v[146:147], v[254:255], v[82:83], v[146:147] op_sel_hi:[1,0,1]
    v_pk_fma_f32 v[164:165], v[32:33], v[82:83], v[164:165] op_sel_hi:[1,0,1]
    v_pk_fma_f32 v[166:167], v[34:35], v[82:83], v[166:167] op_sel_hi:[1,0,1]
    v_pk_fma_f32 v[184:185], v[36:37], v[82:83], v[184:185] op_sel_hi:[1,0,1]
    v_pk_fma_f32 v[186:187], v[38:39], v[82:83], v[186:187] op_sel_hi:[1,0,1]
    v_cvt_pk_bf16_f32 v100, v124, v125
    v_cvt_pk_bf16_f32 v101, v126, v127
    v_cvt_pk_bf16_f32 v102, v144, v145
    v_cvt_pk_bf16_f32 v103, v146, v147
    v_cvt_pk_bf16_f32 v104, v164, v165
    v_cvt_pk_bf16_f32 v105, v166, v167
    v_cvt_pk_bf16_f32 v106, v184, v185
    v_cvt_pk_bf16_f32 v107, v186, v187
    ds_write_b128 v193, v[100:103] offset:3072
    ds_write_b128 v193, v[104:107] offset:8192
    v_pk_mul_f32 v[128:129], v[128:129], v[74:75] op_sel_hi:[1,0]
    v_pk_mul_f32 v[130:131], v[130:131], v[74:75] op_sel_hi:[1,0]
    v_pk_mul_f32 v[148:149], v[148:149], v[74:75] op_sel_hi:[1,0]
    v_pk_mul_f32 v[150:151], v[150:151], v[74:75] op_sel_hi:[1,0]
    v_pk_mul_f32 v[168:169], v[168:169], v[74:75] op_sel_hi:[1,0]
    v_pk_mul_f32 v[170:171], v[170:171], v[74:75] op_sel_hi:[1,0]
    v_pk_mul_f32 v[188:189], v[188:189], v[74:75] op_sel_hi:[1,0]
    v_pk_mul_f32 v[190:191], v[190:191], v[74:75] op_sel_hi:[1,0]
    v_pk_fma_f32 v[128:129], v[40:41], v[84:85], v[128:129] op_sel_hi:[1,0,1]
    v_pk_fma_f32 v[130:131], v[42:43], v[84:85], v[130:131] op_sel_hi:[1,0,1]
    v_pk_fma_f32 v[148:149], v[44:45], v[84:85], v[148:149] op_sel_hi:[1,0,1]
    v_pk_fma_f32 v[150:151], v[46:47], v[84:85], v[150:151] op_sel_hi:[1,0,1]
    v_pk_fma_f32 v[168:169], v[48:49], v[84:85], v[168:169] op_sel_hi:[1,0,1]
    v_pk_fma_f32 v[170:171], v[50:51], v[84:85], v[170:171] op_sel_hi:[1,0,1]
    v_pk_fma_f32 v[188:189], v[62:63], v[84:85], v[188:189] op_sel_hi:[1,0,1]
    v_pk_fma_f32 v[190:191], v[64:65], v[84:85], v[190:191] op_sel_hi:[1,0,1]
    v_cvt_pk_bf16_f32 v92, v128, v129
    v_cvt_pk_bf16_f32 v93, v130, v131
    v_cvt_pk_bf16_f32 v94, v148, v149
    v_cvt_pk_bf16_f32 v95, v150, v151
    v_cvt_pk_bf16_f32 v96, v168, v169
    v_cvt_pk_bf16_f32 v97, v170, v171
    v_cvt_pk_bf16_f32 v98, v188, v189
    v_cvt_pk_bf16_f32 v99, v190, v191
    ds_write_b128 v193, v[92:95] offset:4096
    ds_write_b128 v193, v[96:99] offset:9216
    v_lshlrev_b32 v20, 4, v1
    s_mul_i32 s9, s6, 2560
    s_add_u32 s9, s9, s42
    v_add_u32 v28, s9, v20
    v_add_u32 v20, 122880, v20
    v_lshlrev_b32 v29, 3, v1
    v_add_u32 v29, s9, v29
    s_lshl_b32 s37, 1, s5
    v_mov_b32 v6, s37
    v_lshlrev_b32 v7, 7, v1
    s_waitcnt vmcnt(0) lgkmcnt(0)
    s_barrier

    ds_read_b64_tr_b16 a[160:161], v25 offset:0
    ds_read_b64_tr_b16 a[162:163], v25 offset:2048
    ds_read_b128 a[0:3], v20 offset:0
    ds_read_b128 a[4:7], v20 offset:1024
    ds_read_b128 a[8:11], v20 offset:2048
    ds_read_b128 a[12:15], v20 offset:3072
    ds_read_b128 a[16:19], v20 offset:4096
    ds_read_b64_tr_b16 a[164:165], v25 offset:4096
    ds_read_b64_tr_b16 a[166:167], v25 offset:6144
    ds_read_b128 a[20:23], v20 offset:5120
    ds_read_b128 a[24:27], v20 offset:6144
    ds_read_b128 a[28:31], v20 offset:7168
    ds_read_b128 a[32:35], v20 offset:8192
    ds_read_b128 a[36:39], v20 offset:9216
    s_add_u32 m0, s33, 65536
    s_lshl_b32 s9, s50, 7
    s_add_u32 s9, s9, s35
    s_add_u32 s10, s9, 0
    buffer_load_dwordx4 v23, s[24:27], s10 offen offset:0  lds
    s_add_u32 s10, s9, 8192
    buffer_load_dwordx4 v23, s[24:27], s10 offen offset:1024  lds
    s_add_u32 s10, s9, 16384
    buffer_load_dwordx4 v23, s[24:27], s10 offen offset:2048  lds
    s_add_u32 s10, s9, 24576
    buffer_load_dwordx4 v23, s[24:27], s10 offen offset:3072  lds
    s_waitcnt lgkmcnt(7)
    v_mfma_f32_16x16x32_bf16 v[32:35], a[160:163], a[0:3], 0
    ds_read_b64_tr_b16 a[168:169], v25 offset:8192
    ds_read_b64_tr_b16 a[170:171], v25 offset:10240
    v_mfma_f32_16x16x32_bf16 v[36:39], a[160:163], a[4:7], 0
    ds_read_b128 a[40:43], v20 offset:10240
    ds_read_b128 a[44:47], v20 offset:11264
    v_mfma_f32_16x16x32_bf16 v[40:43], a[160:163], a[8:11], 0
    ds_read_b128 a[48:51], v20 offset:12288
    ds_read_b128 a[52:55], v20 offset:13312
    v_mfma_f32_16x16x32_bf16 v[44:47], a[160:163], a[12:15], 0
    ds_read_b128 a[56:59], v20 offset:14336
    v_mfma_f32_16x16x32_bf16 v[48:51], a[160:163], a[16:19], 0
    s_add_u32 m0, s33, 69632
    s_lshl_b32 s9, s50, 7
    s_add_u32 s9, s9, s35
    s_add_u32 s10, s9, 36864
    buffer_load_dwordx4 v23, s[24:27], s10 offen offset:0  lds
    s_waitcnt lgkmcnt(7)
    v_mfma_f32_16x16x32_bf16 v[32:35], a[164:167], a[20:23], v[32:35]
    ds_read_b64_tr_b16 a[172:173], v25 offset:12288
    ds_read_b64_tr_b16 a[174:175], v25 offset:14336
    v_mfma_f32_16x16x32_bf16 v[36:39], a[164:167], a[24:27], v[36:39]
    ds_read_b128 a[60:63], v20 offset:15360
    ds_read_b128 a[64:67], v20 offset:16384
    v_mfma_f32_16x16x32_bf16 v[40:43], a[164:167], a[28:31], v[40:43]
    ds_read_b128 a[68:71], v20 offset:17408
    ds_read_b128 a[72:75], v20 offset:18432
    v_mfma_f32_16x16x32_bf16 v[44:47], a[164:167], a[32:35], v[44:47]
    ds_read_b128 a[76:79], v20 offset:19456
    v_mfma_f32_16x16x32_bf16 v[48:51], a[164:167], a[36:39], v[48:51]
    s_add_u32 s10, s9, 45056
    buffer_load_dwordx4 v23, s[24:27], s10 offen offset:1024  lds
    s_waitcnt lgkmcnt(7)
    v_mfma_f32_16x16x32_bf16 v[32:35], a[168:171], a[40:43], v[32:35]
    ds_read_b64_tr_b16 a[176:177], v25 offset:16384
    ds_read_b64_tr_b16 a[178:179], v25 offset:18432
    v_mfma_f32_16x16x32_bf16 v[36:39], a[168:171], a[44:47], v[36:39]
    ds_read_b128 a[80:83], v20 offset:20480
    ds_read_b128 a[84:87], v20 offset:21504
    v_mfma_f32_16x16x32_bf16 v[40:43], a[168:171], a[48:51], v[40:43]
    ds_read_b128 a[88:91], v20 offset:22528
    ds_read_b128 a[92:95], v20 offset:23552
    v_mfma_f32_16x16x32_bf16 v[44:47], a[168:171], a[52:55], v[44:47]
    ds_read_b128 a[96:99], v20 offset:24576
    v_mfma_f32_16x16x32_bf16 v[48:51], a[168:171], a[56:59], v[48:51]
    s_add_u32 s10, s9, 53248
    buffer_load_dwordx4 v23, s[24:27], s10 offen offset:2048  lds
    s_waitcnt lgkmcnt(7)
    v_mfma_f32_16x16x32_bf16 v[32:35], a[172:175], a[60:63], v[32:35]
    ds_read_b64_tr_b16 a[180:181], v25 offset:20480
    ds_read_b64_tr_b16 a[182:183], v25 offset:22528
    v_mfma_f32_16x16x32_bf16 v[36:39], a[172:175], a[64:67], v[36:39]
    ds_read_b128 a[100:103], v20 offset:25600
    ds_read_b128 a[104:107], v20 offset:26624
    v_mfma_f32_16x16x32_bf16 v[40:43], a[172:175], a[68:71], v[40:43]
    ds_read_b128 a[108:111], v20 offset:27648
    ds_read_b128 a[112:115], v20 offset:28672
    v_mfma_f32_16x16x32_bf16 v[44:47], a[172:175], a[72:75], v[44:47]
    ds_read_b128 a[116:119], v20 offset:29696
    v_mfma_f32_16x16x32_bf16 v[48:51], a[172:175], a[76:79], v[48:51]
    s_add_u32 s10, s9, 61440
    buffer_load_dwordx4 v23, s[24:27], s10 offen offset:3072  lds
    s_waitcnt lgkmcnt(7)
    v_mfma_f32_16x16x32_bf16 v[32:35], a[176:179], a[80:83], v[32:35]
    ds_read_b64_tr_b16 a[184:185], v25 offset:24576
    ds_read_b64_tr_b16 a[186:187], v25 offset:26624
    v_mfma_f32_16x16x32_bf16 v[36:39], a[176:179], a[84:87], v[36:39]
    ds_read_b128 a[120:123], v20 offset:30720
    ds_read_b128 a[124:127], v20 offset:31744
    v_mfma_f32_16x16x32_bf16 v[40:43], a[176:179], a[88:91], v[40:43]
    ds_read_b128 a[128:131], v20 offset:32768
    ds_read_b128 a[132:135], v20 offset:33792
    v_mfma_f32_16x16x32_bf16 v[44:47], a[176:179], a[92:95], v[44:47]
    ds_read_b128 a[136:139], v20 offset:34816
    v_mfma_f32_16x16x32_bf16 v[48:51], a[176:179], a[96:99], v[48:51]
    s_waitcnt lgkmcnt(7)
    v_mfma_f32_16x16x32_bf16 v[32:35], a[180:183], a[100:103], v[32:35]
    ds_read_b64_tr_b16 a[188:189], v25 offset:28672
    ds_read_b64_tr_b16 a[190:191], v25 offset:30720
    v_mfma_f32_16x16x32_bf16 v[36:39], a[180:183], a[104:107], v[36:39]
    ds_read_b128 a[140:143], v20 offset:35840
    ds_read_b128 a[144:147], v20 offset:36864
    v_mfma_f32_16x16x32_bf16 v[40:43], a[180:183], a[108:111], v[40:43]
    ds_read_b128 a[148:151], v20 offset:37888
    ds_read_b128 a[152:155], v20 offset:38912
    v_mfma_f32_16x16x32_bf16 v[44:47], a[180:183], a[112:115], v[44:47]
    ds_read_b128 a[156:159], v20 offset:39936
    v_mfma_f32_16x16x32_bf16 v[48:51], a[180:183], a[116:119], v[48:51]
    s_waitcnt lgkmcnt(7)
    v_mfma_f32_16x16x32_bf16 v[32:35], a[184:187], a[120:123], v[32:35]
    ds_read_b64_tr_b16 a[192:193], v25 offset:32768
    ds_read_b64_tr_b16 a[194:195], v25 offset:34816
    v_mfma_f32_16x16x32_bf16 v[36:39], a[184:187], a[124:127], v[36:39]
    ds_read_b64_tr_b16 a[196:197], v25 offset:36864
    ds_read_b64_tr_b16 a[198:199], v25 offset:38912
    v_mfma_f32_16x16x32_bf16 v[40:43], a[184:187], a[128:131], v[40:43]
    ds_read_b64_tr_b16 a[200:201], v25 offset:40960
    ds_read_b64_tr_b16 a[202:203], v25 offset:43008
    v_mfma_f32_16x16x32_bf16 v[44:47], a[184:187], a[132:135], v[44:47]
    ds_read_b64_tr_b16 a[204:205], v25 offset:45056
    ds_read_b64_tr_b16 a[206:207], v25 offset:47104
    v_mfma_f32_16x16x32_bf16 v[48:51], a[184:187], a[136:139], v[48:51]
    s_waitcnt lgkmcnt(8)
    v_mfma_f32_16x16x32_bf16 v[32:35], a[188:191], a[140:143], v[32:35]
    ds_read_b64_tr_b16 a[208:209], v25 offset:49152
    ds_read_b64_tr_b16 a[210:211], v25 offset:51200
    v_mfma_f32_16x16x32_bf16 v[36:39], a[188:191], a[144:147], v[36:39]
    ds_read_b64_tr_b16 a[212:213], v25 offset:53248
    ds_read_b64_tr_b16 a[214:215], v25 offset:55296
    v_mfma_f32_16x16x32_bf16 v[40:43], a[188:191], a[148:151], v[40:43]
    ds_read_b64_tr_b16 a[216:217], v25 offset:57344
    ds_read_b64_tr_b16 a[218:219], v25 offset:59392
    v_mfma_f32_16x16x32_bf16 v[44:47], a[188:191], a[152:155], v[44:47]
    ds_read_b64_tr_b16 a[220:221], v25 offset:61440
    ds_read_b64_tr_b16 a[222:223], v25 offset:63488
    v_mfma_f32_16x16x32_bf16 v[48:51], a[188:191], a[156:159], v[48:51]
    s_waitcnt lgkmcnt(0)
    s_barrier
    v_mfma_f32_16x16x32_bf16 v[52:55], a[192:195], a[0:3], 0
    s_add_u32 m0, s33, 98304
    s_lshl_b32 s9, s51, 7
    s_add_u32 s9, s9, s35
    s_add_u32 s10, s9, 0
    buffer_load_dwordx4 v23, s[24:27], s10 offen offset:0  lds
    v_mfma_f32_16x16x32_bf16 v[52:55], a[196:199], a[20:23], v[52:55]
    v_mfma_f32_16x16x32_bf16 v[52:55], a[200:203], a[40:43], v[52:55]
    s_add_u32 s10, s9, 8192
    buffer_load_dwordx4 v23, s[24:27], s10 offen offset:1024  lds
    v_mfma_f32_16x16x32_bf16 v[52:55], a[204:207], a[60:63], v[52:55]
    v_mfma_f32_16x16x32_bf16 v[52:55], a[208:211], a[80:83], v[52:55]
    s_add_u32 s10, s9, 16384
    buffer_load_dwordx4 v23, s[24:27], s10 offen offset:2048  lds
    v_mfma_f32_16x16x32_bf16 v[52:55], a[212:215], a[100:103], v[52:55]
    s_add_u32 s10, s9, 24576
    buffer_load_dwordx4 v23, s[24:27], s10 offen offset:3072  lds
    v_mfma_f32_16x16x32_bf16 v[52:55], a[216:219], a[120:123], v[52:55]
    v_mfma_f32_16x16x32_bf16 v[52:55], a[220:223], a[140:143], v[52:55]
    s_add_u32 m0, s33, 102400
    s_lshl_b32 s9, s51, 7
    s_add_u32 s9, s9, s35
    s_add_u32 s10, s9, 36864
    buffer_load_dwordx4 v23, s[24:27], s10 offen offset:0  lds
    v_mfma_f32_16x16x32_bf16 v[56:59], a[192:195], a[4:7], 0
    v_mfma_f32_16x16x32_bf16 v[56:59], a[196:199], a[24:27], v[56:59]
    s_add_u32 s10, s9, 45056
    buffer_load_dwordx4 v23, s[24:27], s10 offen offset:1024  lds
    v_mfma_f32_16x16x32_bf16 v[56:59], a[200:203], a[44:47], v[56:59]
    s_add_u32 s10, s9, 53248
    buffer_load_dwordx4 v23, s[24:27], s10 offen offset:2048  lds
    v_mfma_f32_16x16x32_bf16 v[56:59], a[204:207], a[64:67], v[56:59]
    v_mfma_f32_16x16x32_bf16 v[56:59], a[208:211], a[84:87], v[56:59]
    s_add_u32 s10, s9, 61440
    buffer_load_dwordx4 v23, s[24:27], s10 offen offset:3072  lds
    v_mfma_f32_16x16x32_bf16 v[56:59], a[212:215], a[104:107], v[56:59]
    v_mfma_f32_16x16x32_bf16 v[56:59], a[216:219], a[124:127], v[56:59]
    s_add_u32 m0, s33, 131072
    s_lshl_b32 s9, s52, 7
    s_add_u32 s9, s9, s35
    s_add_u32 s10, s9, 0
    buffer_load_dwordx4 v23, s[24:27], s10 offen offset:0  lds
    v_mfma_f32_16x16x32_bf16 v[56:59], a[220:223], a[144:147], v[56:59]
    s_add_u32 s10, s9, 8192
    buffer_load_dwordx4 v23, s[24:27], s10 offen offset:1024  lds
    v_mfma_f32_16x16x32_bf16 v[60:63], a[192:195], a[8:11], 0
    v_mfma_f32_16x16x32_bf16 v[60:63], a[196:199], a[28:31], v[60:63]
    s_add_u32 s10, s9, 16384
    buffer_load_dwordx4 v23, s[24:27], s10 offen offset:2048  lds
    v_mfma_f32_16x16x32_bf16 v[60:63], a[200:203], a[48:51], v[60:63]
    v_mfma_f32_16x16x32_bf16 v[60:63], a[204:207], a[68:71], v[60:63]
    s_add_u32 s10, s9, 24576
    buffer_load_dwordx4 v23, s[24:27], s10 offen offset:3072  lds
    s_waitcnt vmcnt(12)
    s_barrier
    v_mfma_f32_16x16x32_bf16 v[60:63], a[208:211], a[88:91], v[60:63]
    ds_read_b64_tr_b16 a[160:161], v26 offset:0
    ds_read_b64_tr_b16 a[162:163], v26 offset:2048
    v_mfma_f32_16x16x32_bf16 v[60:63], a[212:215], a[108:111], v[60:63]
    ds_read_b64_tr_b16 a[164:165], v26 offset:4096
    v_mfma_f32_16x16x32_bf16 v[60:63], a[216:219], a[128:131], v[60:63]
    ds_read_b64_tr_b16 a[166:167], v26 offset:6144
    ds_read_b64_tr_b16 a[168:169], v26 offset:8192
    v_mfma_f32_16x16x32_bf16 v[60:63], a[220:223], a[148:151], v[60:63]
    ds_read_b64_tr_b16 a[170:171], v26 offset:10240
    ds_read_b64_tr_b16 a[172:173], v26 offset:12288
    v_mfma_f32_16x16x32_bf16 v[64:67], a[192:195], a[12:15], 0
    ds_read_b64_tr_b16 a[174:175], v26 offset:14336
    ds_read_b64_tr_b16 a[176:177], v26 offset:16384
    v_mfma_f32_16x16x32_bf16 v[64:67], a[196:199], a[32:35], v[64:67]
    ds_read_b64_tr_b16 a[178:179], v26 offset:18432
    v_mfma_f32_16x16x32_bf16 v[64:67], a[200:203], a[52:55], v[64:67]
    ds_read_b64_tr_b16 a[180:181], v26 offset:20480
    ds_read_b64_tr_b16 a[182:183], v26 offset:22528
    v_mfma_f32_16x16x32_bf16 v[64:67], a[204:207], a[72:75], v[64:67]
    ds_read_b64_tr_b16 a[184:185], v26 offset:24576
    ds_read_b64_tr_b16 a[186:187], v26 offset:26624
    v_mfma_f32_16x16x32_bf16 v[64:67], a[208:211], a[92:95], v[64:67]
    ds_read_b64_tr_b16 a[188:189], v26 offset:28672
    ds_read_b64_tr_b16 a[190:191], v26 offset:30720
    v_mfma_f32_16x16x32_bf16 v[64:67], a[212:215], a[112:115], v[64:67]
    v_cvt_pk_bf16_f32 v72, v32, v33
    v_mfma_f32_16x16x32_bf16 v[64:67], a[216:219], a[132:135], v[64:67]
    v_cvt_pk_bf16_f32 v73, v34, v35
    v_cvt_pk_bf16_f32 v74, v36, v37
    v_mfma_f32_16x16x32_bf16 v[64:67], a[220:223], a[152:155], v[64:67]
    v_cvt_pk_bf16_f32 v75, v38, v39
    v_cvt_pk_bf16_f32 v76, v40, v41
    v_mfma_f32_16x16x32_bf16 v[68:71], a[192:195], a[16:19], 0
    v_cvt_pk_bf16_f32 v77, v42, v43
    v_cvt_pk_bf16_f32 v78, v44, v45
    v_mfma_f32_16x16x32_bf16 v[68:71], a[196:199], a[36:39], v[68:71]
    v_cvt_pk_bf16_f32 v79, v46, v47
    v_mfma_f32_16x16x32_bf16 v[68:71], a[200:203], a[56:59], v[68:71]
    v_cvt_pk_bf16_f32 v80, v48, v49
    v_cvt_pk_bf16_f32 v81, v50, v51
    v_mfma_f32_16x16x32_bf16 v[68:71], a[204:207], a[76:79], v[68:71]
    s_mov_b32 s11, 0
    v_mfma_f32_16x16x32_bf16 v[68:71], a[208:211], a[96:99], v[68:71]
    buffer_store_dwordx4 v[72:75], v28, s[28:31], s11 offen sc1
    v_mfma_f32_16x16x32_bf16 v[68:71], a[212:215], a[116:119], v[68:71]
    buffer_store_dwordx4 v[76:79], v28, s[28:31], s11 offen offset:1024 sc1
    v_mfma_f32_16x16x32_bf16 v[68:71], a[216:219], a[136:139], v[68:71]
    buffer_store_dwordx2 v[80:81], v29, s[28:31], s11 offen offset:2048 sc1
    v_mfma_f32_16x16x32_bf16 v[68:71], a[220:223], a[156:159], v[68:71]
    s_waitcnt lgkmcnt(0)
    v_mfma_f32_16x16x32_bf16 v[32:35], a[160:163], a[0:3], 0
    s_add_u32 m0, s33, 135168
    s_lshl_b32 s9, s52, 7
    s_add_u32 s9, s9, s35
    s_add_u32 s10, s9, 36864
    buffer_load_dwordx4 v23, s[24:27], s10 offen offset:0  lds
    v_mfma_f32_16x16x32_bf16 v[32:35], a[164:167], a[20:23], v[32:35]
    v_mfma_f32_16x16x32_bf16 v[32:35], a[168:171], a[40:43], v[32:35]
    s_add_u32 s10, s9, 45056
    buffer_load_dwordx4 v23, s[24:27], s10 offen offset:1024  lds
    v_mfma_f32_16x16x32_bf16 v[32:35], a[172:175], a[60:63], v[32:35]
    v_mfma_f32_16x16x32_bf16 v[32:35], a[176:179], a[80:83], v[32:35]
    s_add_u32 s10, s9, 53248
    buffer_load_dwordx4 v23, s[24:27], s10 offen offset:2048  lds
    v_mfma_f32_16x16x32_bf16 v[32:35], a[180:183], a[100:103], v[32:35]
    v_mfma_f32_16x16x32_bf16 v[32:35], a[184:187], a[120:123], v[32:35]
    s_add_u32 s10, s9, 61440
    buffer_load_dwordx4 v23, s[24:27], s10 offen offset:3072  lds
    v_mfma_f32_16x16x32_bf16 v[32:35], a[188:191], a[140:143], v[32:35]
    v_mfma_f32_16x16x32_bf16 v[36:39], a[160:163], a[4:7], 0
    s_add_u32 m0, s33, 0
    s_lshl_b32 s9, s53, 7
    s_add_u32 s9, s9, s35
    s_add_u32 s10, s9, 0
    buffer_load_dwordx4 v23, s[24:27], s10 offen offset:0  lds
    v_mfma_f32_16x16x32_bf16 v[36:39], a[164:167], a[24:27], v[36:39]
    v_mfma_f32_16x16x32_bf16 v[36:39], a[168:171], a[44:47], v[36:39]
    s_add_u32 s10, s9, 8192
    buffer_load_dwordx4 v23, s[24:27], s10 offen offset:1024  lds
    v_mfma_f32_16x16x32_bf16 v[36:39], a[172:175], a[64:67], v[36:39]
    v_mfma_f32_16x16x32_bf16 v[36:39], a[176:179], a[84:87], v[36:39]
    s_add_u32 s10, s9, 16384
    buffer_load_dwordx4 v23, s[24:27], s10 offen offset:2048  lds
    v_mfma_f32_16x16x32_bf16 v[36:39], a[180:183], a[104:107], v[36:39]
    v_mfma_f32_16x16x32_bf16 v[36:39], a[184:187], a[124:127], v[36:39]
    s_add_u32 s10, s9, 24576
    buffer_load_dwordx4 v23, s[24:27], s10 offen offset:3072  lds
    v_mfma_f32_16x16x32_bf16 v[36:39], a[188:191], a[144:147], v[36:39]
    s_waitcnt vmcnt(15)
    s_barrier
    v_mfma_f32_16x16x32_bf16 v[40:43], a[160:163], a[8:11], 0
    ds_read_b64_tr_b16 a[192:193], v26 offset:32768
    v_mfma_f32_16x16x32_bf16 v[40:43], a[164:167], a[28:31], v[40:43]
    ds_read_b64_tr_b16 a[194:195], v26 offset:34816
    ds_read_b64_tr_b16 a[196:197], v26 offset:36864
    v_mfma_f32_16x16x32_bf16 v[40:43], a[168:171], a[48:51], v[40:43]
    ds_read_b64_tr_b16 a[198:199], v26 offset:38912
    v_mfma_f32_16x16x32_bf16 v[40:43], a[172:175], a[68:71], v[40:43]
    ds_read_b64_tr_b16 a[200:201], v26 offset:40960
    ds_read_b64_tr_b16 a[202:203], v26 offset:43008
    v_mfma_f32_16x16x32_bf16 v[40:43], a[176:179], a[88:91], v[40:43]
    ds_read_b64_tr_b16 a[204:205], v26 offset:45056
    v_mfma_f32_16x16x32_bf16 v[40:43], a[180:183], a[108:111], v[40:43]
    ds_read_b64_tr_b16 a[206:207], v26 offset:47104
    ds_read_b64_tr_b16 a[208:209], v26 offset:49152
    v_mfma_f32_16x16x32_bf16 v[40:43], a[184:187], a[128:131], v[40:43]
    ds_read_b64_tr_b16 a[210:211], v26 offset:51200
    v_mfma_f32_16x16x32_bf16 v[40:43], a[188:191], a[148:151], v[40:43]
    ds_read_b64_tr_b16 a[212:213], v26 offset:53248
    v_mfma_f32_16x16x32_bf16 v[44:47], a[160:163], a[12:15], 0
    ds_read_b64_tr_b16 a[214:215], v26 offset:55296
    ds_read_b64_tr_b16 a[216:217], v26 offset:57344
    v_mfma_f32_16x16x32_bf16 v[44:47], a[164:167], a[32:35], v[44:47]
    ds_read_b64_tr_b16 a[218:219], v26 offset:59392
    v_mfma_f32_16x16x32_bf16 v[44:47], a[168:171], a[52:55], v[44:47]
    ds_read_b64_tr_b16 a[220:221], v26 offset:61440
    ds_read_b64_tr_b16 a[222:223], v26 offset:63488
    v_mfma_f32_16x16x32_bf16 v[44:47], a[172:175], a[72:75], v[44:47]
    v_cvt_pk_bf16_f32 v84, v52, v53
    v_mfma_f32_16x16x32_bf16 v[44:47], a[176:179], a[92:95], v[44:47]
    v_cvt_pk_bf16_f32 v85, v54, v55
    v_cvt_pk_bf16_f32 v86, v56, v57
    v_mfma_f32_16x16x32_bf16 v[44:47], a[180:183], a[112:115], v[44:47]
    v_cvt_pk_bf16_f32 v87, v58, v59
    v_mfma_f32_16x16x32_bf16 v[44:47], a[184:187], a[132:135], v[44:47]
    v_cvt_pk_bf16_f32 v88, v60, v61
    v_cvt_pk_bf16_f32 v89, v62, v63
    v_mfma_f32_16x16x32_bf16 v[44:47], a[188:191], a[152:155], v[44:47]
    v_cvt_pk_bf16_f32 v90, v64, v65
    v_mfma_f32_16x16x32_bf16 v[48:51], a[160:163], a[16:19], 0
    v_cvt_pk_bf16_f32 v91, v66, v67
    v_mfma_f32_16x16x32_bf16 v[48:51], a[164:167], a[36:39], v[48:51]
    v_cvt_pk_bf16_f32 v92, v68, v69
    v_cvt_pk_bf16_f32 v93, v70, v71
    v_mfma_f32_16x16x32_bf16 v[48:51], a[168:171], a[56:59], v[48:51]
    s_mov_b32 s11, 10240
    v_mfma_f32_16x16x32_bf16 v[48:51], a[172:175], a[76:79], v[48:51]
    buffer_store_dwordx4 v[84:87], v28, s[28:31], s11 offen sc1
    v_mfma_f32_16x16x32_bf16 v[48:51], a[176:179], a[96:99], v[48:51]
    buffer_store_dwordx4 v[88:91], v28, s[28:31], s11 offen offset:1024 sc1
    v_mfma_f32_16x16x32_bf16 v[48:51], a[180:183], a[116:119], v[48:51]
    v_mfma_f32_16x16x32_bf16 v[48:51], a[184:187], a[136:139], v[48:51]
    buffer_store_dwordx2 v[92:93], v29, s[28:31], s11 offen offset:2048 sc1
    v_mfma_f32_16x16x32_bf16 v[48:51], a[188:191], a[156:159], v[48:51]
    s_waitcnt lgkmcnt(0)
    v_mfma_f32_16x16x32_bf16 v[52:55], a[192:195], a[0:3], 0
    s_add_u32 m0, s33, 4096
    s_lshl_b32 s9, s53, 7
    s_add_u32 s9, s9, s35
    s_add_u32 s10, s9, 36864
    buffer_load_dwordx4 v23, s[24:27], s10 offen offset:0  lds
    v_mfma_f32_16x16x32_bf16 v[52:55], a[196:199], a[20:23], v[52:55]
    v_mfma_f32_16x16x32_bf16 v[52:55], a[200:203], a[40:43], v[52:55]
    s_add_u32 s10, s9, 45056
    buffer_load_dwordx4 v23, s[24:27], s10 offen offset:1024  lds
    v_mfma_f32_16x16x32_bf16 v[52:55], a[204:207], a[60:63], v[52:55]
    v_mfma_f32_16x16x32_bf16 v[52:55], a[208:211], a[80:83], v[52:55]
    s_add_u32 s10, s9, 53248
    buffer_load_dwordx4 v23, s[24:27], s10 offen offset:2048  lds
    v_mfma_f32_16x16x32_bf16 v[52:55], a[212:215], a[100:103], v[52:55]
    v_mfma_f32_16x16x32_bf16 v[52:55], a[216:219], a[120:123], v[52:55]
    s_add_u32 s10, s9, 61440
    buffer_load_dwordx4 v23, s[24:27], s10 offen offset:3072  lds
    v_mfma_f32_16x16x32_bf16 v[52:55], a[220:223], a[140:143], v[52:55]
    v_mfma_f32_16x16x32_bf16 v[56:59], a[192:195], a[4:7], 0
    s_add_u32 m0, s33, 32768
    s_lshl_b32 s9, s54, 7
    s_add_u32 s9, s9, s35
    s_add_u32 s10, s9, 0
    buffer_load_dwordx4 v23, s[24:27], s10 offen offset:0  lds
    v_mfma_f32_16x16x32_bf16 v[56:59], a[196:199], a[24:27], v[56:59]
    v_mfma_f32_16x16x32_bf16 v[56:59], a[200:203], a[44:47], v[56:59]
    s_add_u32 s10, s9, 8192
    buffer_load_dwordx4 v23, s[24:27], s10 offen offset:1024  lds
    v_mfma_f32_16x16x32_bf16 v[56:59], a[204:207], a[64:67], v[56:59]
    v_mfma_f32_16x16x32_bf16 v[56:59], a[208:211], a[84:87], v[56:59]
    s_add_u32 s10, s9, 16384
    buffer_load_dwordx4 v23, s[24:27], s10 offen offset:2048  lds
    v_mfma_f32_16x16x32_bf16 v[56:59], a[212:215], a[104:107], v[56:59]
    v_mfma_f32_16x16x32_bf16 v[56:59], a[216:219], a[124:127], v[56:59]
    s_add_u32 s10, s9, 24576
    buffer_load_dwordx4 v23, s[24:27], s10 offen offset:3072  lds
    v_mfma_f32_16x16x32_bf16 v[56:59], a[220:223], a[144:147], v[56:59]
    s_waitcnt vmcnt(15)
    s_barrier
    v_mfma_f32_16x16x32_bf16 v[60:63], a[192:195], a[8:11], 0
    ds_read_b64_tr_b16 a[160:161], v27 offset:0
    v_mfma_f32_16x16x32_bf16 v[60:63], a[196:199], a[28:31], v[60:63]
    ds_read_b64_tr_b16 a[162:163], v27 offset:2048
    ds_read_b64_tr_b16 a[164:165], v27 offset:4096
    v_mfma_f32_16x16x32_bf16 v[60:63], a[200:203], a[48:51], v[60:63]
    ds_read_b64_tr_b16 a[166:167], v27 offset:6144
    v_mfma_f32_16x16x32_bf16 v[60:63], a[204:207], a[68:71], v[60:63]
    ds_read_b64_tr_b16 a[168:169], v27 offset:8192
    ds_read_b64_tr_b16 a[170:171], v27 offset:10240
    v_mfma_f32_16x16x32_bf16 v[60:63], a[208:211], a[88:91], v[60:63]
    ds_read_b64_tr_b16 a[172:173], v27 offset:12288
    v_mfma_f32_16x16x32_bf16 v[60:63], a[212:215], a[108:111], v[60:63]
    ds_read_b64_tr_b16 a[174:175], v27 offset:14336
    ds_read_b64_tr_b16 a[176:177], v27 offset:16384
    v_mfma_f32_16x16x32_bf16 v[60:63], a[216:219], a[128:131], v[60:63]
    ds_read_b64_tr_b16 a[178:179], v27 offset:18432
    v_mfma_f32_16x16x32_bf16 v[60:63], a[220:223], a[148:151], v[60:63]
    ds_read_b64_tr_b16 a[180:181], v27 offset:20480
    v_mfma_f32_16x16x32_bf16 v[64:67], a[192:195], a[12:15], 0
    ds_read_b64_tr_b16 a[182:183], v27 offset:22528
    ds_read_b64_tr_b16 a[184:185], v27 offset:24576
    v_mfma_f32_16x16x32_bf16 v[64:67], a[196:199], a[32:35], v[64:67]
    ds_read_b64_tr_b16 a[186:187], v27 offset:26624
    v_mfma_f32_16x16x32_bf16 v[64:67], a[200:203], a[52:55], v[64:67]
    ds_read_b64_tr_b16 a[188:189], v27 offset:28672
    ds_read_b64_tr_b16 a[190:191], v27 offset:30720
    v_mfma_f32_16x16x32_bf16 v[64:67], a[204:207], a[72:75], v[64:67]
    v_cvt_pk_bf16_f32 v72, v32, v33
    v_mfma_f32_16x16x32_bf16 v[64:67], a[208:211], a[92:95], v[64:67]
    v_cvt_pk_bf16_f32 v73, v34, v35
    v_cvt_pk_bf16_f32 v74, v36, v37
    v_mfma_f32_16x16x32_bf16 v[64:67], a[212:215], a[112:115], v[64:67]
    v_cvt_pk_bf16_f32 v75, v38, v39
    v_mfma_f32_16x16x32_bf16 v[64:67], a[216:219], a[132:135], v[64:67]
    v_cvt_pk_bf16_f32 v76, v40, v41
    v_cvt_pk_bf16_f32 v77, v42, v43
    v_mfma_f32_16x16x32_bf16 v[64:67], a[220:223], a[152:155], v[64:67]
    v_cvt_pk_bf16_f32 v78, v44, v45
    v_mfma_f32_16x16x32_bf16 v[68:71], a[192:195], a[16:19], 0
    v_cvt_pk_bf16_f32 v79, v46, v47
    v_mfma_f32_16x16x32_bf16 v[68:71], a[196:199], a[36:39], v[68:71]
    v_cvt_pk_bf16_f32 v80, v48, v49
    v_cvt_pk_bf16_f32 v81, v50, v51
    v_mfma_f32_16x16x32_bf16 v[68:71], a[200:203], a[56:59], v[68:71]
    s_mov_b32 s11, 20480
    v_mfma_f32_16x16x32_bf16 v[68:71], a[204:207], a[76:79], v[68:71]
    buffer_store_dwordx4 v[72:75], v28, s[28:31], s11 offen sc1
    v_mfma_f32_16x16x32_bf16 v[68:71], a[208:211], a[96:99], v[68:71]
    buffer_store_dwordx4 v[76:79], v28, s[28:31], s11 offen offset:1024 sc1
    v_mfma_f32_16x16x32_bf16 v[68:71], a[212:215], a[116:119], v[68:71]
    v_mfma_f32_16x16x32_bf16 v[68:71], a[216:219], a[136:139], v[68:71]
    buffer_store_dwordx2 v[80:81], v29, s[28:31], s11 offen offset:2048 sc1
    v_mfma_f32_16x16x32_bf16 v[68:71], a[220:223], a[156:159], v[68:71]
    s_waitcnt lgkmcnt(0)
    v_mfma_f32_16x16x32_bf16 v[32:35], a[160:163], a[0:3], 0
    s_add_u32 m0, s33, 36864
    s_lshl_b32 s9, s54, 7
    s_add_u32 s9, s9, s35
    s_add_u32 s10, s9, 36864
    buffer_load_dwordx4 v23, s[24:27], s10 offen offset:0  lds
    v_mfma_f32_16x16x32_bf16 v[32:35], a[164:167], a[20:23], v[32:35]
    v_mfma_f32_16x16x32_bf16 v[32:35], a[168:171], a[40:43], v[32:35]
    s_add_u32 s10, s9, 45056
    buffer_load_dwordx4 v23, s[24:27], s10 offen offset:1024  lds
    v_mfma_f32_16x16x32_bf16 v[32:35], a[172:175], a[60:63], v[32:35]
    v_mfma_f32_16x16x32_bf16 v[32:35], a[176:179], a[80:83], v[32:35]
    s_add_u32 s10, s9, 53248
    buffer_load_dwordx4 v23, s[24:27], s10 offen offset:2048  lds
    v_mfma_f32_16x16x32_bf16 v[32:35], a[180:183], a[100:103], v[32:35]
    v_mfma_f32_16x16x32_bf16 v[32:35], a[184:187], a[120:123], v[32:35]
    s_add_u32 s10, s9, 61440
    buffer_load_dwordx4 v23, s[24:27], s10 offen offset:3072  lds
    v_mfma_f32_16x16x32_bf16 v[32:35], a[188:191], a[140:143], v[32:35]
    v_mfma_f32_16x16x32_bf16 v[36:39], a[160:163], a[4:7], 0
    s_add_u32 m0, s33, 65536
    s_lshl_b32 s9, s55, 7
    s_add_u32 s9, s9, s35
    s_add_u32 s10, s9, 0
    buffer_load_dwordx4 v23, s[24:27], s10 offen offset:0  lds
    v_mfma_f32_16x16x32_bf16 v[36:39], a[164:167], a[24:27], v[36:39]
    v_mfma_f32_16x16x32_bf16 v[36:39], a[168:171], a[44:47], v[36:39]
    s_add_u32 s10, s9, 8192
    buffer_load_dwordx4 v23, s[24:27], s10 offen offset:1024  lds
    v_mfma_f32_16x16x32_bf16 v[36:39], a[172:175], a[64:67], v[36:39]
    v_mfma_f32_16x16x32_bf16 v[36:39], a[176:179], a[84:87], v[36:39]
    s_add_u32 s10, s9, 16384
    buffer_load_dwordx4 v23, s[24:27], s10 offen offset:2048  lds
    v_mfma_f32_16x16x32_bf16 v[36:39], a[180:183], a[104:107], v[36:39]
    v_mfma_f32_16x16x32_bf16 v[36:39], a[184:187], a[124:127], v[36:39]
    s_add_u32 s10, s9, 24576
    buffer_load_dwordx4 v23, s[24:27], s10 offen offset:3072  lds
    v_mfma_f32_16x16x32_bf16 v[36:39], a[188:191], a[144:147], v[36:39]
    s_waitcnt vmcnt(15)
    s_barrier
    v_mfma_f32_16x16x32_bf16 v[40:43], a[160:163], a[8:11], 0
    ds_read_b64_tr_b16 a[192:193], v25 offset:0
    v_mfma_f32_16x16x32_bf16 v[40:43], a[164:167], a[28:31], v[40:43]
    ds_read_b64_tr_b16 a[194:195], v25 offset:2048
    ds_read_b64_tr_b16 a[196:197], v25 offset:4096
    v_mfma_f32_16x16x32_bf16 v[40:43], a[168:171], a[48:51], v[40:43]
    ds_read_b64_tr_b16 a[198:199], v25 offset:6144
    v_mfma_f32_16x16x32_bf16 v[40:43], a[172:175], a[68:71], v[40:43]
    ds_read_b64_tr_b16 a[200:201], v25 offset:8192
    ds_read_b64_tr_b16 a[202:203], v25 offset:10240
    v_mfma_f32_16x16x32_bf16 v[40:43], a[176:179], a[88:91], v[40:43]
    ds_read_b64_tr_b16 a[204:205], v25 offset:12288
    v_mfma_f32_16x16x32_bf16 v[40:43], a[180:183], a[108:111], v[40:43]
    ds_read_b64_tr_b16 a[206:207], v25 offset:14336
    ds_read_b64_tr_b16 a[208:209], v25 offset:16384
    v_mfma_f32_16x16x32_bf16 v[40:43], a[184:187], a[128:131], v[40:43]
    ds_read_b64_tr_b16 a[210:211], v25 offset:18432
    v_mfma_f32_16x16x32_bf16 v[40:43], a[188:191], a[148:151], v[40:43]
    ds_read_b64_tr_b16 a[212:213], v25 offset:20480
    v_mfma_f32_16x16x32_bf16 v[44:47], a[160:163], a[12:15], 0
    ds_read_b64_tr_b16 a[214:215], v25 offset:22528
    ds_read_b64_tr_b16 a[216:217], v25 offset:24576
    v_mfma_f32_16x16x32_bf16 v[44:47], a[164:167], a[32:35], v[44:47]
    ds_read_b64_tr_b16 a[218:219], v25 offset:26624
    v_mfma_f32_16x16x32_bf16 v[44:47], a[168:171], a[52:55], v[44:47]
    ds_read_b64_tr_b16 a[220:221], v25 offset:28672
    ds_read_b64_tr_b16 a[222:223], v25 offset:30720
    v_mfma_f32_16x16x32_bf16 v[44:47], a[172:175], a[72:75], v[44:47]
    v_cvt_pk_bf16_f32 v84, v52, v53
    v_mfma_f32_16x16x32_bf16 v[44:47], a[176:179], a[92:95], v[44:47]
    v_cvt_pk_bf16_f32 v85, v54, v55
    v_cvt_pk_bf16_f32 v86, v56, v57
    v_mfma_f32_16x16x32_bf16 v[44:47], a[180:183], a[112:115], v[44:47]
    v_cvt_pk_bf16_f32 v87, v58, v59
    v_mfma_f32_16x16x32_bf16 v[44:47], a[184:187], a[132:135], v[44:47]
    v_cvt_pk_bf16_f32 v88, v60, v61
    v_cvt_pk_bf16_f32 v89, v62, v63
    v_mfma_f32_16x16x32_bf16 v[44:47], a[188:191], a[152:155], v[44:47]
    v_cvt_pk_bf16_f32 v90, v64, v65
    v_mfma_f32_16x16x32_bf16 v[48:51], a[160:163], a[16:19], 0
    v_cvt_pk_bf16_f32 v91, v66, v67
    v_mfma_f32_16x16x32_bf16 v[48:51], a[164:167], a[36:39], v[48:51]
    v_cvt_pk_bf16_f32 v92, v68, v69
    v_cvt_pk_bf16_f32 v93, v70, v71
    v_mfma_f32_16x16x32_bf16 v[48:51], a[168:171], a[56:59], v[48:51]
    s_mov_b32 s11, 30720
    v_mfma_f32_16x16x32_bf16 v[48:51], a[172:175], a[76:79], v[48:51]
    buffer_store_dwordx4 v[84:87], v28, s[28:31], s11 offen sc1
    v_mfma_f32_16x16x32_bf16 v[48:51], a[176:179], a[96:99], v[48:51]
    buffer_store_dwordx4 v[88:91], v28, s[28:31], s11 offen offset:1024 sc1
    v_mfma_f32_16x16x32_bf16 v[48:51], a[180:183], a[116:119], v[48:51]
    v_mfma_f32_16x16x32_bf16 v[48:51], a[184:187], a[136:139], v[48:51]
    buffer_store_dwordx2 v[92:93], v29, s[28:31], s11 offen offset:2048 sc1
    v_mfma_f32_16x16x32_bf16 v[48:51], a[188:191], a[156:159], v[48:51]
    s_waitcnt lgkmcnt(0)
    v_mfma_f32_16x16x32_bf16 v[52:55], a[192:195], a[0:3], 0
    s_add_u32 m0, s33, 69632
    s_lshl_b32 s9, s55, 7
    s_add_u32 s9, s9, s35
    s_add_u32 s10, s9, 36864
    buffer_load_dwordx4 v23, s[24:27], s10 offen offset:0  lds
    v_mfma_f32_16x16x32_bf16 v[52:55], a[196:199], a[20:23], v[52:55]
    v_mfma_f32_16x16x32_bf16 v[52:55], a[200:203], a[40:43], v[52:55]
    s_add_u32 s10, s9, 45056
    buffer_load_dwordx4 v23, s[24:27], s10 offen offset:1024  lds
    v_mfma_f32_16x16x32_bf16 v[52:55], a[204:207], a[60:63], v[52:55]
    v_mfma_f32_16x16x32_bf16 v[52:55], a[208:211], a[80:83], v[52:55]
    s_add_u32 s10, s9, 53248
    buffer_load_dwordx4 v23, s[24:27], s10 offen offset:2048  lds
    v_mfma_f32_16x16x32_bf16 v[52:55], a[212:215], a[100:103], v[52:55]
    v_mfma_f32_16x16x32_bf16 v[52:55], a[216:219], a[120:123], v[52:55]
    s_add_u32 s10, s9, 61440
    buffer_load_dwordx4 v23, s[24:27], s10 offen offset:3072  lds
    v_mfma_f32_16x16x32_bf16 v[52:55], a[220:223], a[140:143], v[52:55]
    v_mfma_f32_16x16x32_bf16 v[56:59], a[192:195], a[4:7], 0
    s_add_u32 m0, s33, 98304
    s_lshl_b32 s9, s56, 7
    s_add_u32 s9, s9, s35
    s_add_u32 s10, s9, 0
    buffer_load_dwordx4 v23, s[24:27], s10 offen offset:0  lds
    v_mfma_f32_16x16x32_bf16 v[56:59], a[196:199], a[24:27], v[56:59]
    v_mfma_f32_16x16x32_bf16 v[56:59], a[200:203], a[44:47], v[56:59]
    s_add_u32 s10, s9, 8192
    buffer_load_dwordx4 v23, s[24:27], s10 offen offset:1024  lds
    v_mfma_f32_16x16x32_bf16 v[56:59], a[204:207], a[64:67], v[56:59]
    v_mfma_f32_16x16x32_bf16 v[56:59], a[208:211], a[84:87], v[56:59]
    s_add_u32 s10, s9, 16384
    buffer_load_dwordx4 v23, s[24:27], s10 offen offset:2048  lds
    v_mfma_f32_16x16x32_bf16 v[56:59], a[212:215], a[104:107], v[56:59]
    v_mfma_f32_16x16x32_bf16 v[56:59], a[216:219], a[124:127], v[56:59]
    s_add_u32 s10, s9, 24576
    buffer_load_dwordx4 v23, s[24:27], s10 offen offset:3072  lds
    v_mfma_f32_16x16x32_bf16 v[56:59], a[220:223], a[144:147], v[56:59]
    s_waitcnt vmcnt(15)
    s_barrier
    v_mfma_f32_16x16x32_bf16 v[60:63], a[192:195], a[8:11], 0
    ds_read_b64_tr_b16 a[160:161], v25 offset:32768
    v_mfma_f32_16x16x32_bf16 v[60:63], a[196:199], a[28:31], v[60:63]
    ds_read_b64_tr_b16 a[162:163], v25 offset:34816
    ds_read_b64_tr_b16 a[164:165], v25 offset:36864
    v_mfma_f32_16x16x32_bf16 v[60:63], a[200:203], a[48:51], v[60:63]
    ds_read_b64_tr_b16 a[166:167], v25 offset:38912
    v_mfma_f32_16x16x32_bf16 v[60:63], a[204:207], a[68:71], v[60:63]
    ds_read_b64_tr_b16 a[168:169], v25 offset:40960
    ds_read_b64_tr_b16 a[170:171], v25 offset:43008
    v_mfma_f32_16x16x32_bf16 v[60:63], a[208:211], a[88:91], v[60:63]
    ds_read_b64_tr_b16 a[172:173], v25 offset:45056
    v_mfma_f32_16x16x32_bf16 v[60:63], a[212:215], a[108:111], v[60:63]
    ds_read_b64_tr_b16 a[174:175], v25 offset:47104
    ds_read_b64_tr_b16 a[176:177], v25 offset:49152
    v_mfma_f32_16x16x32_bf16 v[60:63], a[216:219], a[128:131], v[60:63]
    ds_read_b64_tr_b16 a[178:179], v25 offset:51200
    v_mfma_f32_16x16x32_bf16 v[60:63], a[220:223], a[148:151], v[60:63]
    ds_read_b64_tr_b16 a[180:181], v25 offset:53248
    v_mfma_f32_16x16x32_bf16 v[64:67], a[192:195], a[12:15], 0
    ds_read_b64_tr_b16 a[182:183], v25 offset:55296
    ds_read_b64_tr_b16 a[184:185], v25 offset:57344
    v_mfma_f32_16x16x32_bf16 v[64:67], a[196:199], a[32:35], v[64:67]
    ds_read_b64_tr_b16 a[186:187], v25 offset:59392
    v_mfma_f32_16x16x32_bf16 v[64:67], a[200:203], a[52:55], v[64:67]
    ds_read_b64_tr_b16 a[188:189], v25 offset:61440
    ds_read_b64_tr_b16 a[190:191], v25 offset:63488
    v_mfma_f32_16x16x32_bf16 v[64:67], a[204:207], a[72:75], v[64:67]
    v_cvt_pk_bf16_f32 v72, v32, v33
    v_mfma_f32_16x16x32_bf16 v[64:67], a[208:211], a[92:95], v[64:67]
    v_cvt_pk_bf16_f32 v73, v34, v35
    v_cvt_pk_bf16_f32 v74, v36, v37
    v_mfma_f32_16x16x32_bf16 v[64:67], a[212:215], a[112:115], v[64:67]
    v_cvt_pk_bf16_f32 v75, v38, v39
    v_mfma_f32_16x16x32_bf16 v[64:67], a[216:219], a[132:135], v[64:67]
    v_cvt_pk_bf16_f32 v76, v40, v41
    v_cvt_pk_bf16_f32 v77, v42, v43
    v_mfma_f32_16x16x32_bf16 v[64:67], a[220:223], a[152:155], v[64:67]
    v_cvt_pk_bf16_f32 v78, v44, v45
    v_mfma_f32_16x16x32_bf16 v[68:71], a[192:195], a[16:19], 0
    v_cvt_pk_bf16_f32 v79, v46, v47
    v_mfma_f32_16x16x32_bf16 v[68:71], a[196:199], a[36:39], v[68:71]
    v_cvt_pk_bf16_f32 v80, v48, v49
    v_cvt_pk_bf16_f32 v81, v50, v51
    v_mfma_f32_16x16x32_bf16 v[68:71], a[200:203], a[56:59], v[68:71]
    s_mov_b32 s11, 40960
    v_mfma_f32_16x16x32_bf16 v[68:71], a[204:207], a[76:79], v[68:71]
    buffer_store_dwordx4 v[72:75], v28, s[28:31], s11 offen sc1
    v_mfma_f32_16x16x32_bf16 v[68:71], a[208:211], a[96:99], v[68:71]
    buffer_store_dwordx4 v[76:79], v28, s[28:31], s11 offen offset:1024 sc1
    v_mfma_f32_16x16x32_bf16 v[68:71], a[212:215], a[116:119], v[68:71]
    v_mfma_f32_16x16x32_bf16 v[68:71], a[216:219], a[136:139], v[68:71]
    buffer_store_dwordx2 v[80:81], v29, s[28:31], s11 offen offset:2048 sc1
    v_mfma_f32_16x16x32_bf16 v[68:71], a[220:223], a[156:159], v[68:71]
    s_waitcnt lgkmcnt(0)
    v_mfma_f32_16x16x32_bf16 v[32:35], a[160:163], a[0:3], 0
    v_mfma_f32_16x16x32_bf16 v[32:35], a[164:167], a[20:23], v[32:35]
    s_add_u32 m0, s33, 102400
    s_lshl_b32 s9, s56, 7
    s_add_u32 s9, s9, s35
    s_add_u32 s10, s9, 36864
    buffer_load_dwordx4 v23, s[24:27], s10 offen offset:0  lds
    v_mfma_f32_16x16x32_bf16 v[32:35], a[168:171], a[40:43], v[32:35]
    v_mfma_f32_16x16x32_bf16 v[32:35], a[172:175], a[60:63], v[32:35]
    v_mfma_f32_16x16x32_bf16 v[32:35], a[176:179], a[80:83], v[32:35]
    v_mfma_f32_16x16x32_bf16 v[32:35], a[180:183], a[100:103], v[32:35]
    s_add_u32 s10, s9, 45056
    buffer_load_dwordx4 v23, s[24:27], s10 offen offset:1024  lds
    v_mfma_f32_16x16x32_bf16 v[32:35], a[184:187], a[120:123], v[32:35]
    v_mfma_f32_16x16x32_bf16 v[32:35], a[188:191], a[140:143], v[32:35]
    v_mfma_f32_16x16x32_bf16 v[36:39], a[160:163], a[4:7], 0
    v_mfma_f32_16x16x32_bf16 v[36:39], a[164:167], a[24:27], v[36:39]
    s_add_u32 s10, s9, 53248
    buffer_load_dwordx4 v23, s[24:27], s10 offen offset:2048  lds
    v_mfma_f32_16x16x32_bf16 v[36:39], a[168:171], a[44:47], v[36:39]
    v_mfma_f32_16x16x32_bf16 v[36:39], a[172:175], a[64:67], v[36:39]
    v_mfma_f32_16x16x32_bf16 v[36:39], a[176:179], a[84:87], v[36:39]
    v_mfma_f32_16x16x32_bf16 v[36:39], a[180:183], a[104:107], v[36:39]
    s_add_u32 s10, s9, 61440
    buffer_load_dwordx4 v23, s[24:27], s10 offen offset:3072  lds
    v_mfma_f32_16x16x32_bf16 v[36:39], a[184:187], a[124:127], v[36:39]
    v_mfma_f32_16x16x32_bf16 v[36:39], a[188:191], a[144:147], v[36:39]
    s_waitcnt vmcnt(11)
    s_barrier
    v_mfma_f32_16x16x32_bf16 v[40:43], a[160:163], a[8:11], 0
    ds_read_b64_tr_b16 a[192:193], v26 offset:0
    v_mfma_f32_16x16x32_bf16 v[40:43], a[164:167], a[28:31], v[40:43]
    ds_read_b64_tr_b16 a[194:195], v26 offset:2048
    ds_read_b64_tr_b16 a[196:197], v26 offset:4096
    v_mfma_f32_16x16x32_bf16 v[40:43], a[168:171], a[48:51], v[40:43]
    ds_read_b64_tr_b16 a[198:199], v26 offset:6144
    v_mfma_f32_16x16x32_bf16 v[40:43], a[172:175], a[68:71], v[40:43]
    ds_read_b64_tr_b16 a[200:201], v26 offset:8192
    ds_read_b64_tr_b16 a[202:203], v26 offset:10240
    v_mfma_f32_16x16x32_bf16 v[40:43], a[176:179], a[88:91], v[40:43]
    ds_read_b64_tr_b16 a[204:205], v26 offset:12288
    v_mfma_f32_16x16x32_bf16 v[40:43], a[180:183], a[108:111], v[40:43]
    ds_read_b64_tr_b16 a[206:207], v26 offset:14336
    ds_read_b64_tr_b16 a[208:209], v26 offset:16384
    v_mfma_f32_16x16x32_bf16 v[40:43], a[184:187], a[128:131], v[40:43]
    ds_read_b64_tr_b16 a[210:211], v26 offset:18432
    v_mfma_f32_16x16x32_bf16 v[40:43], a[188:191], a[148:151], v[40:43]
    ds_read_b64_tr_b16 a[212:213], v26 offset:20480
    v_mfma_f32_16x16x32_bf16 v[44:47], a[160:163], a[12:15], 0
    ds_read_b64_tr_b16 a[214:215], v26 offset:22528
    ds_read_b64_tr_b16 a[216:217], v26 offset:24576
    v_mfma_f32_16x16x32_bf16 v[44:47], a[164:167], a[32:35], v[44:47]
    ds_read_b64_tr_b16 a[218:219], v26 offset:26624
    v_mfma_f32_16x16x32_bf16 v[44:47], a[168:171], a[52:55], v[44:47]
    ds_read_b64_tr_b16 a[220:221], v26 offset:28672
    ds_read_b64_tr_b16 a[222:223], v26 offset:30720
    v_mfma_f32_16x16x32_bf16 v[44:47], a[172:175], a[72:75], v[44:47]
    v_cvt_pk_bf16_f32 v84, v52, v53
    v_mfma_f32_16x16x32_bf16 v[44:47], a[176:179], a[92:95], v[44:47]
    v_cvt_pk_bf16_f32 v85, v54, v55
    v_cvt_pk_bf16_f32 v86, v56, v57
    v_mfma_f32_16x16x32_bf16 v[44:47], a[180:183], a[112:115], v[44:47]
    v_cvt_pk_bf16_f32 v87, v58, v59
    v_mfma_f32_16x16x32_bf16 v[44:47], a[184:187], a[132:135], v[44:47]
    v_cvt_pk_bf16_f32 v88, v60, v61
    v_cvt_pk_bf16_f32 v89, v62, v63
    v_mfma_f32_16x16x32_bf16 v[44:47], a[188:191], a[152:155], v[44:47]
    v_cvt_pk_bf16_f32 v90, v64, v65
    v_mfma_f32_16x16x32_bf16 v[48:51], a[160:163], a[16:19], 0
    v_cvt_pk_bf16_f32 v91, v66, v67
    v_mfma_f32_16x16x32_bf16 v[48:51], a[164:167], a[36:39], v[48:51]
    v_cvt_pk_bf16_f32 v92, v68, v69
    v_cvt_pk_bf16_f32 v93, v70, v71
    v_mfma_f32_16x16x32_bf16 v[48:51], a[168:171], a[56:59], v[48:51]
    s_mov_b32 s11, 51200
    v_mfma_f32_16x16x32_bf16 v[48:51], a[172:175], a[76:79], v[48:51]
    buffer_store_dwordx4 v[84:87], v28, s[28:31], s11 offen sc1
    v_mfma_f32_16x16x32_bf16 v[48:51], a[176:179], a[96:99], v[48:51]
    buffer_store_dwordx4 v[88:91], v28, s[28:31], s11 offen offset:1024 sc1
    v_mfma_f32_16x16x32_bf16 v[48:51], a[180:183], a[116:119], v[48:51]
    v_mfma_f32_16x16x32_bf16 v[48:51], a[184:187], a[136:139], v[48:51]
    buffer_store_dwordx2 v[92:93], v29, s[28:31], s11 offen offset:2048 sc1
    v_mfma_f32_16x16x32_bf16 v[48:51], a[188:191], a[156:159], v[48:51]
    s_waitcnt lgkmcnt(0)
    v_mfma_f32_16x16x32_bf16 v[52:55], a[192:195], a[0:3], 0
    v_mfma_f32_16x16x32_bf16 v[52:55], a[196:199], a[20:23], v[52:55]
    v_mfma_f32_16x16x32_bf16 v[52:55], a[200:203], a[40:43], v[52:55]
    v_mfma_f32_16x16x32_bf16 v[52:55], a[204:207], a[60:63], v[52:55]
    v_mfma_f32_16x16x32_bf16 v[52:55], a[208:211], a[80:83], v[52:55]
    v_mfma_f32_16x16x32_bf16 v[52:55], a[212:215], a[100:103], v[52:55]
    v_mfma_f32_16x16x32_bf16 v[52:55], a[216:219], a[120:123], v[52:55]
    v_mfma_f32_16x16x32_bf16 v[52:55], a[220:223], a[140:143], v[52:55]
    v_mfma_f32_16x16x32_bf16 v[56:59], a[192:195], a[4:7], 0
    v_mfma_f32_16x16x32_bf16 v[56:59], a[196:199], a[24:27], v[56:59]
    v_mfma_f32_16x16x32_bf16 v[56:59], a[200:203], a[44:47], v[56:59]
    v_mfma_f32_16x16x32_bf16 v[56:59], a[204:207], a[64:67], v[56:59]
    v_mfma_f32_16x16x32_bf16 v[56:59], a[208:211], a[84:87], v[56:59]
    v_mfma_f32_16x16x32_bf16 v[56:59], a[212:215], a[104:107], v[56:59]
    v_mfma_f32_16x16x32_bf16 v[56:59], a[216:219], a[124:127], v[56:59]
    v_mfma_f32_16x16x32_bf16 v[56:59], a[220:223], a[144:147], v[56:59]
    s_waitcnt vmcnt(3)
    s_barrier
    v_mfma_f32_16x16x32_bf16 v[60:63], a[192:195], a[8:11], 0
    ds_read_b64_tr_b16 a[160:161], v26 offset:32768
    v_mfma_f32_16x16x32_bf16 v[60:63], a[196:199], a[28:31], v[60:63]
    ds_read_b64_tr_b16 a[162:163], v26 offset:34816
    ds_read_b64_tr_b16 a[164:165], v26 offset:36864
    v_mfma_f32_16x16x32_bf16 v[60:63], a[200:203], a[48:51], v[60:63]
    ds_read_b64_tr_b16 a[166:167], v26 offset:38912
    v_mfma_f32_16x16x32_bf16 v[60:63], a[204:207], a[68:71], v[60:63]
    ds_read_b64_tr_b16 a[168:169], v26 offset:40960
    ds_read_b64_tr_b16 a[170:171], v26 offset:43008
    v_mfma_f32_16x16x32_bf16 v[60:63], a[208:211], a[88:91], v[60:63]
    ds_read_b64_tr_b16 a[172:173], v26 offset:45056
    v_mfma_f32_16x16x32_bf16 v[60:63], a[212:215], a[108:111], v[60:63]
    ds_read_b64_tr_b16 a[174:175], v26 offset:47104
    ds_read_b64_tr_b16 a[176:177], v26 offset:49152
    v_mfma_f32_16x16x32_bf16 v[60:63], a[216:219], a[128:131], v[60:63]
    ds_read_b64_tr_b16 a[178:179], v26 offset:51200
    v_mfma_f32_16x16x32_bf16 v[60:63], a[220:223], a[148:151], v[60:63]
    ds_read_b64_tr_b16 a[180:181], v26 offset:53248
    v_mfma_f32_16x16x32_bf16 v[64:67], a[192:195], a[12:15], 0
    ds_read_b64_tr_b16 a[182:183], v26 offset:55296
    ds_read_b64_tr_b16 a[184:185], v26 offset:57344
    v_mfma_f32_16x16x32_bf16 v[64:67], a[196:199], a[32:35], v[64:67]
    ds_read_b64_tr_b16 a[186:187], v26 offset:59392
    v_mfma_f32_16x16x32_bf16 v[64:67], a[200:203], a[52:55], v[64:67]
    ds_read_b64_tr_b16 a[188:189], v26 offset:61440
    ds_read_b64_tr_b16 a[190:191], v26 offset:63488
    v_mfma_f32_16x16x32_bf16 v[64:67], a[204:207], a[72:75], v[64:67]
    v_cvt_pk_bf16_f32 v72, v32, v33
    v_mfma_f32_16x16x32_bf16 v[64:67], a[208:211], a[92:95], v[64:67]
    v_cvt_pk_bf16_f32 v73, v34, v35
    v_cvt_pk_bf16_f32 v74, v36, v37
    v_mfma_f32_16x16x32_bf16 v[64:67], a[212:215], a[112:115], v[64:67]
    v_cvt_pk_bf16_f32 v75, v38, v39
    v_mfma_f32_16x16x32_bf16 v[64:67], a[216:219], a[132:135], v[64:67]
    v_cvt_pk_bf16_f32 v76, v40, v41
    v_cvt_pk_bf16_f32 v77, v42, v43
    v_mfma_f32_16x16x32_bf16 v[64:67], a[220:223], a[152:155], v[64:67]
    v_cvt_pk_bf16_f32 v78, v44, v45
    v_mfma_f32_16x16x32_bf16 v[68:71], a[192:195], a[16:19], 0
    v_cvt_pk_bf16_f32 v79, v46, v47
    v_mfma_f32_16x16x32_bf16 v[68:71], a[196:199], a[36:39], v[68:71]
    v_cvt_pk_bf16_f32 v80, v48, v49
    v_cvt_pk_bf16_f32 v81, v50, v51
    v_mfma_f32_16x16x32_bf16 v[68:71], a[200:203], a[56:59], v[68:71]
    s_mov_b32 s11, 61440
    v_mfma_f32_16x16x32_bf16 v[68:71], a[204:207], a[76:79], v[68:71]
    buffer_store_dwordx4 v[72:75], v28, s[28:31], s11 offen sc1
    v_mfma_f32_16x16x32_bf16 v[68:71], a[208:211], a[96:99], v[68:71]
    buffer_store_dwordx4 v[76:79], v28, s[28:31], s11 offen offset:1024 sc1
    v_mfma_f32_16x16x32_bf16 v[68:71], a[212:215], a[116:119], v[68:71]
    v_mfma_f32_16x16x32_bf16 v[68:71], a[216:219], a[136:139], v[68:71]
    buffer_store_dwordx2 v[80:81], v29, s[28:31], s11 offen offset:2048 sc1
    v_mfma_f32_16x16x32_bf16 v[68:71], a[220:223], a[156:159], v[68:71]
    s_waitcnt lgkmcnt(0)
    v_mfma_f32_16x16x32_bf16 v[32:35], a[160:163], a[0:3], 0
    v_mfma_f32_16x16x32_bf16 v[32:35], a[164:167], a[20:23], v[32:35]
    v_mfma_f32_16x16x32_bf16 v[32:35], a[168:171], a[40:43], v[32:35]
    v_mfma_f32_16x16x32_bf16 v[32:35], a[172:175], a[60:63], v[32:35]
    v_cvt_pk_bf16_f32 v84, v52, v53
    v_cvt_pk_bf16_f32 v85, v54, v55
    v_cvt_pk_bf16_f32 v86, v56, v57
    v_mfma_f32_16x16x32_bf16 v[32:35], a[176:179], a[80:83], v[32:35]
    v_cvt_pk_bf16_f32 v87, v58, v59
    v_cvt_pk_bf16_f32 v88, v60, v61
    v_cvt_pk_bf16_f32 v89, v62, v63
    v_cvt_pk_bf16_f32 v90, v64, v65
    v_mfma_f32_16x16x32_bf16 v[32:35], a[180:183], a[100:103], v[32:35]
    v_cvt_pk_bf16_f32 v91, v66, v67
    v_cvt_pk_bf16_f32 v92, v68, v69
    v_cvt_pk_bf16_f32 v93, v70, v71
    v_mfma_f32_16x16x32_bf16 v[32:35], a[184:187], a[120:123], v[32:35]
    s_load_dwordx2 s[16:17], s[0:1], 88
    s_load_dwordx2 s[20:21], s[0:1], 80
    s_lshl_b32 s36, s39, 4
    v_mfma_f32_16x16x32_bf16 v[32:35], a[188:191], a[140:143], v[32:35]
    v_mov_b32 v5, 0
    s_lshl_b32 s27, s101, 7
    v_mov_b32 v9, s37
    v_mfma_f32_16x16x32_bf16 v[36:39], a[160:163], a[4:7], 0
    s_mov_b32 s18, 256
    s_mov_b32 s19, 0x20000
    s_mov_b32 s22, 1474560
    s_mov_b32 s23, 0x20000
    v_mfma_f32_16x16x32_bf16 v[36:39], a[164:167], a[24:27], v[36:39]
    s_and_b32 s9, s39, 7
    s_mul_i32 s9, s9, 184320
    s_lshr_b32 s10, s39, 3
    v_mfma_f32_16x16x32_bf16 v[36:39], a[168:171], a[44:47], v[36:39]
    s_mul_i32 s10, s10, 1152
    s_add_u32 s12, s9, s10
    s_mov_b32 s13, s101
    v_mfma_f32_16x16x32_bf16 v[36:39], a[172:175], a[64:67], v[36:39]
    s_mov_b32 s15, 0
    buffer_load_dword v11, v5, s[96:99], s27 offen sc1
    v_mfma_f32_16x16x32_bf16 v[36:39], a[176:179], a[84:87], v[36:39]
    s_mov_b32 s11, 71680
    buffer_store_dwordx4 v[84:87], v28, s[28:31], s11 offen sc1
    v_mfma_f32_16x16x32_bf16 v[36:39], a[180:183], a[104:107], v[36:39]
    buffer_store_dwordx4 v[88:91], v28, s[28:31], s11 offen offset:1024 sc1
    buffer_store_dwordx2 v[92:93], v29, s[28:31], s11 offen offset:2048 sc1
    v_mfma_f32_16x16x32_bf16 v[36:39], a[184:187], a[124:127], v[36:39]
    s_mul_i32 s9, s13, 720
    s_mul_i32 s10, s6, 180
    s_add_u32 s9, s9, s10
    v_mfma_f32_16x16x32_bf16 v[36:39], a[188:191], a[144:147], v[36:39]
    v_lshl_add_u32 v8, v1, 1, s9
    v_lshlrev_b32 v10, 3, v8
    v_min_u32 v17, 51, v1
    v_add3_u32 v17, v17, s9, 64
    v_mfma_f32_16x16x32_bf16 v[40:43], a[160:163], a[8:11], 0
    v_add_u32 v17, 64, v17
    v_lshlrev_b32 v30, 3, v17
    s_mov_b32 s24, 0
    v_mfma_f32_16x16x32_bf16 v[40:43], a[164:167], a[28:31], v[40:43]
    s_mov_b32 s25, 0
    v_mov_b64 v[160:161], 0
    v_mov_b64 v[162:163], 0
    v_mfma_f32_16x16x32_bf16 v[40:43], a[168:171], a[48:51], v[40:43]
    v_mov_b64 v[164:165], 0
    v_mov_b64 v[166:167], 0
    v_mov_b64 v[168:169], 0
    v_mfma_f32_16x16x32_bf16 v[40:43], a[172:175], a[68:71], v[40:43]
    v_mov_b64 v[170:171], 0
    v_mul_u32_u24 v18, 52429, v8
    v_lshrrev_b32 v18, 24, v18
    v_mul_u32_u24 v19, 320, v18
    v_mfma_f32_16x16x32_bf16 v[40:43], a[176:179], a[88:91], v[40:43]
    v_sub_u32 v19, v8, v19
    v_cmp_gt_u32 vcc, 256, v19
    v_bfe_u32 v12, v19, 1, 6
    v_mfma_f32_16x16x32_bf16 v[40:43], a[180:183], a[108:111], v[40:43]
    v_and_b32 v13, 63, v19
    v_cndmask_b32 v12, v13, v12, vcc
    v_and_b32 v13, 1, v19
    v_mfma_f32_16x16x32_bf16 v[40:43], a[184:187], a[128:131], v[40:43]
    v_cndmask_b32 v13, 0, v13, vcc
    v_lshrrev_b32 v19, 7, v19
    v_lshl_add_u32 v19, v19, 1, v13
    v_mfma_f32_16x16x32_bf16 v[40:43], a[188:191], a[148:151], v[40:43]
    v_and_b32 v13, 15, v12
    v_lshl_add_u32 v19, v19, 4, v13
    v_mul_u32_u24 v19, 2304, v19
    v_lshrrev_b32 v12, 4, v12
    v_mfma_f32_16x16x32_bf16 v[44:47], a[160:163], a[12:15], 0
    v_lshl_add_u32 v18, s4, 2, v18
    v_subrev_u32 v13, 36, v18
    v_min_u32 v18, v18, v13
    v_mfma_f32_16x16x32_bf16 v[44:47], a[164:167], a[32:35], v[44:47]
    v_lshlrev_b32 v18, 5, v18
    v_lshl_add_u32 v18, v12, 3, v18
    v_add3_u32 v14, v18, v19, s12
    v_mfma_f32_16x16x32_bf16 v[44:47], a[168:171], a[52:55], v[44:47]
    v_add_u32 v8, 1, v8
    v_mul_u32_u24 v18, 52429, v8
    v_lshrrev_b32 v18, 24, v18
    v_mfma_f32_16x16x32_bf16 v[44:47], a[172:175], a[72:75], v[44:47]
    v_mul_u32_u24 v19, 320, v18
    v_sub_u32 v19, v8, v19
    v_cmp_gt_u32 vcc, 256, v19
    v_bfe_u32 v12, v19, 1, 6
    v_mfma_f32_16x16x32_bf16 v[44:47], a[176:179], a[92:95], v[44:47]
    v_and_b32 v13, 63, v19
    v_cndmask_b32 v12, v13, v12, vcc
    v_and_b32 v13, 1, v19
    v_mfma_f32_16x16x32_bf16 v[44:47], a[180:183], a[112:115], v[44:47]
    v_cndmask_b32 v13, 0, v13, vcc
    v_lshrrev_b32 v19, 7, v19
    v_lshl_add_u32 v19, v19, 1, v13
    v_mfma_f32_16x16x32_bf16 v[44:47], a[184:187], a[132:135], v[44:47]
    v_and_b32 v13, 15, v12
    v_lshl_add_u32 v19, v19, 4, v13
    v_mul_u32_u24 v19, 2304, v19
    v_lshrrev_b32 v12, 4, v12
    v_mfma_f32_16x16x32_bf16 v[44:47], a[188:191], a[152:155], v[44:47]
    v_lshl_add_u32 v18, s4, 2, v18
    v_subrev_u32 v13, 36, v18
    v_min_u32 v18, v18, v13
    v_mfma_f32_16x16x32_bf16 v[48:51], a[160:163], a[16:19], 0
    v_lshlrev_b32 v18, 5, v18
    v_lshl_add_u32 v18, v12, 3, v18
    v_add3_u32 v15, v18, v19, s12
    v_mfma_f32_16x16x32_bf16 v[48:51], a[164:167], a[36:39], v[48:51]
    v_mov_b32 v8, v17
    v_mul_u32_u24 v18, 52429, v8
    v_lshrrev_b32 v18, 24, v18
    v_mfma_f32_16x16x32_bf16 v[48:51], a[168:171], a[56:59], v[48:51]
    v_mul_u32_u24 v19, 320, v18
    v_sub_u32 v19, v8, v19
    v_cmp_gt_u32 vcc, 256, v19
    v_bfe_u32 v12, v19, 1, 6
    v_mfma_f32_16x16x32_bf16 v[48:51], a[172:175], a[76:79], v[48:51]
    v_and_b32 v13, 63, v19
    v_cndmask_b32 v12, v13, v12, vcc
    v_and_b32 v13, 1, v19
    v_mfma_f32_16x16x32_bf16 v[48:51], a[176:179], a[96:99], v[48:51]
    v_cndmask_b32 v13, 0, v13, vcc
    v_lshrrev_b32 v19, 7, v19
    v_lshl_add_u32 v19, v19, 1, v13
    v_mfma_f32_16x16x32_bf16 v[48:51], a[180:183], a[116:119], v[48:51]
    v_and_b32 v13, 15, v12
    v_lshl_add_u32 v19, v19, 4, v13
    v_mul_u32_u24 v19, 2304, v19
    v_mfma_f32_16x16x32_bf16 v[48:51], a[184:187], a[136:139], v[48:51]
    v_lshrrev_b32 v12, 4, v12
    v_lshl_add_u32 v18, s4, 2, v18
    v_subrev_u32 v13, 36, v18
    v_min_u32 v18, v18, v13
    v_mfma_f32_16x16x32_bf16 v[48:51], a[188:191], a[156:159], v[48:51]
    v_lshlrev_b32 v18, 5, v18
    v_lshl_add_u32 v18, v12, 3, v18
    v_add3_u32 v16, v18, v19, s12
    s_nop 7
    v_cvt_pk_bf16_f32 v72, v32, v33
    v_cvt_pk_bf16_f32 v73, v34, v35
    v_cvt_pk_bf16_f32 v74, v36, v37
    v_cvt_pk_bf16_f32 v75, v38, v39
    v_cvt_pk_bf16_f32 v76, v40, v41
    v_cvt_pk_bf16_f32 v77, v42, v43
    v_cvt_pk_bf16_f32 v78, v44, v45
    v_cvt_pk_bf16_f32 v79, v46, v47
    v_cvt_pk_bf16_f32 v80, v48, v49
    v_cvt_pk_bf16_f32 v81, v50, v51
    s_mov_b32 s11, 81920
    buffer_store_dwordx4 v[72:75], v28, s[28:31], s11 offen sc1
    buffer_store_dwordx4 v[76:79], v28, s[28:31], s11 offen offset:1024 sc1
    buffer_store_dwordx2 v[80:81], v29, s[28:31], s11 offen offset:2048 sc1
    s_waitcnt vmcnt(6) lgkmcnt(0)
    v_readfirstlane_b32 s14, v11
    s_and_b32 s17, s17, 0xffff
    s_and_b32 s21, s21, 0xffff
    s_lshr_b32 s10, s14, 1
    s_and_b32 s10, s10, s14
    s_lshr_b32 s11, s10, 2
    s_and_b32 s10, s10, s11
    s_and_b32 s10, s10, 0x1111
    s_andn2_b32 s10, s10, s24

    s_cbranch_scc0 L_q0
    s_ff1_i32_b32 s9, s10
    s_bitset1_b32 s24, s9
    s_mul_i32 s9, s9, 92160
    buffer_load_dwordx4 v[112:115], v10, s[28:31], s9 offen sc1
    buffer_load_dwordx2 v[116:117], v30, s[28:31], s9 offen sc1
    s_add_u32 s9, s9, 92160
    buffer_load_dwordx4 v[118:121], v10, s[28:31], s9 offen sc1
    buffer_load_dwordx2 v[122:123], v30, s[28:31], s9 offen sc1
    s_add_u32 s9, s9, 92160
    buffer_load_dwordx4 v[124:127], v10, s[28:31], s9 offen sc1
    buffer_load_dwordx2 v[128:129], v30, s[28:31], s9 offen sc1
    s_add_u32 s9, s9, 92160
    buffer_load_dwordx4 v[130:133], v10, s[28:31], s9 offen sc1
    buffer_load_dwordx2 v[134:135], v30, s[28:31], s9 offen sc1
    s_waitcnt vmcnt(8)
    s_branch L_q1
L_q0:
    s_waitcnt vmcnt(0)
L_q1:
    s_barrier
    s_cmp_eq_u32 s6, 0
    s_cbranch_scc0 L_q2
    s_mov_b64 exec, 0xffff
    buffer_atomic_or v6, v7, s[96:99], 0 offen
    s_mov_b64 exec, 1
    buffer_atomic_or v9, v5, s[16:19], s36 offen sc0
    s_mov_b64 exec, -1

L_q2:
    s_cmp_lg_u32 s24, 0
    s_cbranch_scc1 L_p0
L_r0:
    s_lshr_b32 s10, s14, 1
    s_and_b32 s10, s10, s14
    s_lshr_b32 s11, s10, 2
    s_and_b32 s10, s10, s11
    s_and_b32 s10, s10, 0x1111
    s_andn2_b32 s10, s10, s24

    s_cbranch_scc1 L_r1
    s_cmp_ge_u32 s25, 4000
    s_cbranch_scc1 L_giveup
    buffer_load_dword v11, v5, s[96:99], s27 offen sc1
    s_add_u32 s25, s25, 1
    s_waitcnt vmcnt(0)
    v_readfirstlane_b32 s14, v11
    s_branch L_r0

L_r1:
    s_ff1_i32_b32 s9, s10
    s_bitset1_b32 s24, s9
    s_mul_i32 s9, s9, 92160
    buffer_load_dwordx4 v[112:115], v10, s[28:31], s9 offen sc1
    buffer_load_dwordx2 v[116:117], v30, s[28:31], s9 offen sc1
    s_add_u32 s9, s9, 92160
    buffer_load_dwordx4 v[118:121], v10, s[28:31], s9 offen sc1
    buffer_load_dwordx2 v[122:123], v30, s[28:31], s9 offen sc1
    s_add_u32 s9, s9, 92160
    buffer_load_dwordx4 v[124:127], v10, s[28:31], s9 offen sc1
    buffer_load_dwordx2 v[128:129], v30, s[28:31], s9 offen sc1
    s_add_u32 s9, s9, 92160
    buffer_load_dwordx4 v[130:133], v10, s[28:31], s9 offen sc1
    buffer_load_dwordx2 v[134:135], v30, s[28:31], s9 offen sc1
L_p0:
    s_lshr_b32 s10, s14, 1
    s_and_b32 s10, s10, s14
    s_lshr_b32 s11, s10, 2
    s_and_b32 s10, s10, s11
    s_and_b32 s10, s10, 0x1111
    s_andn2_b32 s10, s10, s24

    s_cbranch_scc0 L_n0
    s_ff1_i32_b32 s9, s10
    s_bitset1_b32 s24, s9
    s_mul_i32 s9, s9, 92160
    buffer_load_dwordx4 v[136:139], v10, s[28:31], s9 offen sc1
    buffer_load_dwordx2 v[140:141], v30, s[28:31], s9 offen sc1
    s_add_u32 s9, s9, 92160
    buffer_load_dwordx4 v[142:145], v10, s[28:31], s9 offen sc1
    buffer_load_dwordx2 v[146:147], v30, s[28:31], s9 offen sc1
    s_add_u32 s9, s9, 92160
    buffer_load_dwordx4 v[148:151], v10, s[28:31], s9 offen sc1
    buffer_load_dwordx2 v[152:153], v30, s[28:31], s9 offen sc1
    s_add_u32 s9, s9, 92160
    buffer_load_dwordx4 v[154:157], v10, s[28:31], s9 offen sc1
    buffer_load_dwordx2 v[158:159], v30, s[28:31], s9 offen sc1
    s_waitcnt vmcnt(8)
    s_mov_b32 s26, 1
    s_branch L_a0
L_n0:
    buffer_load_dword v11, v5, s[96:99], s27 offen sc1
    s_waitcnt vmcnt(1)
    s_mov_b32 s26, 0
L_a0:
    v_lshlrev_b32 v18, 16, v112
    v_and_b32 v19, 0xffff0000, v112
    v_pk_add_f32 v[160:161], v[160:161], v[18:19]
    v_lshlrev_b32 v20, 16, v113
    v_and_b32 v21, 0xffff0000, v113
    v_pk_add_f32 v[162:163], v[162:163], v[20:21]
    v_lshlrev_b32 v18, 16, v114
    v_and_b32 v19, 0xffff0000, v114
    v_pk_add_f32 v[164:165], v[164:165], v[18:19]
    v_lshlrev_b32 v20, 16, v115
    v_and_b32 v21, 0xffff0000, v115
    v_pk_add_f32 v[166:167], v[166:167], v[20:21]
    v_lshlrev_b32 v18, 16, v116
    v_and_b32 v19, 0xffff0000, v116
    v_pk_add_f32 v[168:169], v[168:169], v[18:19]
    v_lshlrev_b32 v20, 16, v117
    v_and_b32 v21, 0xffff0000, v117
    v_pk_add_f32 v[170:171], v[170:171], v[20:21]
    v_lshlrev_b32 v18, 16, v118
    v_and_b32 v19, 0xffff0000, v118
    v_pk_add_f32 v[160:161], v[160:161], v[18:19]
    v_lshlrev_b32 v20, 16, v119
    v_and_b32 v21, 0xffff0000, v119
    v_pk_add_f32 v[162:163], v[162:163], v[20:21]
    v_lshlrev_b32 v18, 16, v120
    v_and_b32 v19, 0xffff0000, v120
    v_pk_add_f32 v[164:165], v[164:165], v[18:19]
    v_lshlrev_b32 v20, 16, v121
    v_and_b32 v21, 0xffff0000, v121
    v_pk_add_f32 v[166:167], v[166:167], v[20:21]
    v_lshlrev_b32 v18, 16, v122
    v_and_b32 v19, 0xffff0000, v122
    v_pk_add_f32 v[168:169], v[168:169], v[18:19]
    v_lshlrev_b32 v20, 16, v123
    v_and_b32 v21, 0xffff0000, v123
    v_pk_add_f32 v[170:171], v[170:171], v[20:21]
    v_lshlrev_b32 v18, 16, v124
    v_and_b32 v19, 0xffff0000, v124
    v_pk_add_f32 v[160:161], v[160:161], v[18:19]
    v_lshlrev_b32 v20, 16, v125
    v_and_b32 v21, 0xffff0000, v125
    v_pk_add_f32 v[162:163], v[162:163], v[20:21]
    v_lshlrev_b32 v18, 16, v126
    v_and_b32 v19, 0xffff0000, v126
    v_pk_add_f32 v[164:165], v[164:165], v[18:19]
    v_lshlrev_b32 v20, 16, v127
    v_and_b32 v21, 0xffff0000, v127
    v_pk_add_f32 v[166:167], v[166:167], v[20:21]
    v_lshlrev_b32 v18, 16, v128
    v_and_b32 v19, 0xffff0000, v128
    v_pk_add_f32 v[168:169], v[168:169], v[18:19]
    v_lshlrev_b32 v20, 16, v129
    v_and_b32 v21, 0xffff0000, v129
    v_pk_add_f32 v[170:171], v[170:171], v[20:21]
    v_lshlrev_b32 v18, 16, v130
    v_and_b32 v19, 0xffff0000, v130
    v_pk_add_f32 v[160:161], v[160:161], v[18:19]
    v_lshlrev_b32 v20, 16, v131
    v_and_b32 v21, 0xffff0000, v131
    v_pk_add_f32 v[162:163], v[162:163], v[20:21]
    v_lshlrev_b32 v18, 16, v132
    v_and_b32 v19, 0xffff0000, v132
    v_pk_add_f32 v[164:165], v[164:165], v[18:19]
    v_lshlrev_b32 v20, 16, v133
    v_and_b32 v21, 0xffff0000, v133
    v_pk_add_f32 v[166:167], v[166:167], v[20:21]
    v_lshlrev_b32 v18, 16, v134
    v_and_b32 v19, 0xffff0000, v134
    v_pk_add_f32 v[168:169], v[168:169], v[18:19]
    v_lshlrev_b32 v20, 16, v135
    v_and_b32 v21, 0xffff0000, v135
    v_pk_add_f32 v[170:171], v[170:171], v[20:21]
    s_cmp_eq_u32 s26, 1
    s_cbranch_scc0 L_chk
L_p1:
    s_lshr_b32 s10, s14, 1
    s_and_b32 s10, s10, s14
    s_lshr_b32 s11, s10, 2
    s_and_b32 s10, s10, s11
    s_and_b32 s10, s10, 0x1111
    s_andn2_b32 s10, s10, s24

    s_cbranch_scc0 L_n1
    s_ff1_i32_b32 s9, s10
    s_bitset1_b32 s24, s9
    s_mul_i32 s9, s9, 92160
    buffer_load_dwordx4 v[112:115], v10, s[28:31], s9 offen sc1
    buffer_load_dwordx2 v[116:117], v30, s[28:31], s9 offen sc1
    s_add_u32 s9, s9, 92160
    buffer_load_dwordx4 v[118:121], v10, s[28:31], s9 offen sc1
    buffer_load_dwordx2 v[122:123], v30, s[28:31], s9 offen sc1
    s_add_u32 s9, s9, 92160
    buffer_load_dwordx4 v[124:127], v10, s[28:31], s9 offen sc1
    buffer_load_dwordx2 v[128:129], v30, s[28:31], s9 offen sc1
    s_add_u32 s9, s9, 92160
    buffer_load_dwordx4 v[130:133], v10, s[28:31], s9 offen sc1
    buffer_load_dwordx2 v[134:135], v30, s[28:31], s9 offen sc1
    s_waitcnt vmcnt(8)
    s_mov_b32 s26, 1
    s_branch L_a1
L_n1:
    buffer_load_dword v11, v5, s[96:99], s27 offen sc1
    s_waitcnt vmcnt(1)
    s_mov_b32 s26, 0
L_a1:
    v_lshlrev_b32 v18, 16, v136
    v_and_b32 v19, 0xffff0000, v136
    v_pk_add_f32 v[160:161], v[160:161], v[18:19]
    v_lshlrev_b32 v20, 16, v137
    v_and_b32 v21, 0xffff0000, v137
    v_pk_add_f32 v[162:163], v[162:163], v[20:21]
    v_lshlrev_b32 v18, 16, v138
    v_and_b32 v19, 0xffff0000, v138
    v_pk_add_f32 v[164:165], v[164:165], v[18:19]
    v_lshlrev_b32 v20, 16, v139
    v_and_b32 v21, 0xffff0000, v139
    v_pk_add_f32 v[166:167], v[166:167], v[20:21]
    v_lshlrev_b32 v18, 16, v140
    v_and_b32 v19, 0xffff0000, v140
    v_pk_add_f32 v[168:169], v[168:169], v[18:19]
    v_lshlrev_b32 v20, 16, v141
    v_and_b32 v21, 0xffff0000, v141
    v_pk_add_f32 v[170:171], v[170:171], v[20:21]
    v_lshlrev_b32 v18, 16, v142
    v_and_b32 v19, 0xffff0000, v142
    v_pk_add_f32 v[160:161], v[160:161], v[18:19]
    v_lshlrev_b32 v20, 16, v143
    v_and_b32 v21, 0xffff0000, v143
    v_pk_add_f32 v[162:163], v[162:163], v[20:21]
    v_lshlrev_b32 v18, 16, v144
    v_and_b32 v19, 0xffff0000, v144
    v_pk_add_f32 v[164:165], v[164:165], v[18:19]
    v_lshlrev_b32 v20, 16, v145
    v_and_b32 v21, 0xffff0000, v145
    v_pk_add_f32 v[166:167], v[166:167], v[20:21]
    v_lshlrev_b32 v18, 16, v146
    v_and_b32 v19, 0xffff0000, v146
    v_pk_add_f32 v[168:169], v[168:169], v[18:19]
    v_lshlrev_b32 v20, 16, v147
    v_and_b32 v21, 0xffff0000, v147
    v_pk_add_f32 v[170:171], v[170:171], v[20:21]
    v_lshlrev_b32 v18, 16, v148
    v_and_b32 v19, 0xffff0000, v148
    v_pk_add_f32 v[160:161], v[160:161], v[18:19]
    v_lshlrev_b32 v20, 16, v149
    v_and_b32 v21, 0xffff0000, v149
    v_pk_add_f32 v[162:163], v[162:163], v[20:21]
    v_lshlrev_b32 v18, 16, v150
    v_and_b32 v19, 0xffff0000, v150
    v_pk_add_f32 v[164:165], v[164:165], v[18:19]
    v_lshlrev_b32 v20, 16, v151
    v_and_b32 v21, 0xffff0000, v151
    v_pk_add_f32 v[166:167], v[166:167], v[20:21]
    v_lshlrev_b32 v18, 16, v152
    v_and_b32 v19, 0xffff0000, v152
    v_pk_add_f32 v[168:169], v[168:169], v[18:19]
    v_lshlrev_b32 v20, 16, v153
    v_and_b32 v21, 0xffff0000, v153
    v_pk_add_f32 v[170:171], v[170:171], v[20:21]
    v_lshlrev_b32 v18, 16, v154
    v_and_b32 v19, 0xffff0000, v154
    v_pk_add_f32 v[160:161], v[160:161], v[18:19]
    v_lshlrev_b32 v20, 16, v155
    v_and_b32 v21, 0xffff0000, v155
    v_pk_add_f32 v[162:163], v[162:163], v[20:21]
    v_lshlrev_b32 v18, 16, v156
    v_and_b32 v19, 0xffff0000, v156
    v_pk_add_f32 v[164:165], v[164:165], v[18:19]
    v_lshlrev_b32 v20, 16, v157
    v_and_b32 v21, 0xffff0000, v157
    v_pk_add_f32 v[166:167], v[166:167], v[20:21]
    v_lshlrev_b32 v18, 16, v158
    v_and_b32 v19, 0xffff0000, v158
    v_pk_add_f32 v[168:169], v[168:169], v[18:19]
    v_lshlrev_b32 v20, 16, v159
    v_and_b32 v21, 0xffff0000, v159
    v_pk_add_f32 v[170:171], v[170:171], v[20:21]
    s_cmp_eq_u32 s26, 1
    s_cbranch_scc1 L_p0
L_chk:
    s_cmp_eq_u32 s24, 0x1111
    s_cbranch_scc1 L_out
    s_waitcnt vmcnt(0)
    v_readfirstlane_b32 s9, v11
    s_or_b32 s14, s14, s9
    s_branch L_r0
L_out:
    v_cvt_pk_bf16_f32 v172, v160, v161
    v_cvt_pk_bf16_f32 v173, v162, v163
    buffer_store_dwordx2 v[172:173], v14, s[20:23], 0 offen
    v_cvt_pk_bf16_f32 v174, v164, v165
    v_cvt_pk_bf16_f32 v175, v166, v167
    buffer_store_dwordx2 v[174:175], v15, s[20:23], 0 offen
    v_cvt_pk_bf16_f32 v176, v168, v169
    v_cvt_pk_bf16_f32 v177, v170, v171
    buffer_store_dwordx2 v[176:177], v16, s[20:23], 0 offen
L_next:
    s_mov_b64 exec, -1
    s_cmp_lg_u32 s37, 0
    s_cbranch_scc0 L_more
    s_cmp_eq_u32 s6, 0
    s_cbranch_scc0 L_nx1
    s_waitcnt vmcnt(3)
    v_readfirstlane_b32 s9, v9
    s_or_b32 s10, s9, s37
    s_lshr_b32 s9, s9, 16
    s_and_b32 s10, s10, 0xffff
    s_cmp_eq_u32 s10, 0xffff
    s_cselect_b32 s9, s9, 0
    v_mov_b32 v6, s9
    ds_write_b32 v5, v6

L_nx1:
    s_mov_b32 s37, 0
    s_waitcnt lgkmcnt(0)
    s_barrier
    ds_read_b32 v6, v5
    s_waitcnt lgkmcnt(0)
    v_readfirstlane_b32 s15, v6

L_more:
    s_cmp_eq_u32 s15, 0
    s_cbranch_scc1 L_fin
    s_ff1_i32_b32 s13, s15
    s_bitset0_b32 s15, s13
    s_mov_b32 s14, 0xffff
    s_waitcnt vmcnt(0)

    s_mul_i32 s9, s13, 720
    s_mul_i32 s10, s6, 180
    s_add_u32 s9, s9, s10
    v_lshl_add_u32 v8, v1, 1, s9
    v_lshlrev_b32 v10, 3, v8
    v_min_u32 v17, 51, v1
    v_add3_u32 v17, v17, s9, 64
    v_add_u32 v17, 64, v17
    v_lshlrev_b32 v30, 3, v17
    s_mov_b32 s24, 0
    s_mov_b32 s25, 0
    v_mov_b64 v[160:161], 0
    v_mov_b64 v[162:163], 0
    v_mov_b64 v[164:165], 0
    v_mov_b64 v[166:167], 0
    v_mov_b64 v[168:169], 0
    v_mov_b64 v[170:171], 0
    v_mul_u32_u24 v18, 52429, v8
    v_lshrrev_b32 v18, 24, v18
    v_mul_u32_u24 v19, 320, v18
    v_sub_u32 v19, v8, v19
    v_cmp_gt_u32 vcc, 256, v19
    v_bfe_u32 v12, v19, 1, 6
    v_and_b32 v13, 63, v19
    v_cndmask_b32 v12, v13, v12, vcc
    v_and_b32 v13, 1, v19
    v_cndmask_b32 v13, 0, v13, vcc
    v_lshrrev_b32 v19, 7, v19
    v_lshl_add_u32 v19, v19, 1, v13
    v_and_b32 v13, 15, v12
    v_lshl_add_u32 v19, v19, 4, v13
    v_mul_u32_u24 v19, 2304, v19
    v_lshrrev_b32 v12, 4, v12
    v_lshl_add_u32 v18, s4, 2, v18
    v_subrev_u32 v13, 36, v18
    v_min_u32 v18, v18, v13
    v_lshlrev_b32 v18, 5, v18
    v_lshl_add_u32 v18, v12, 3, v18
    v_add3_u32 v14, v18, v19, s12
    v_add_u32 v8, 1, v8
    v_mul_u32_u24 v18, 52429, v8
    v_lshrrev_b32 v18, 24, v18
    v_mul_u32_u24 v19, 320, v18
    v_sub_u32 v19, v8, v19
    v_cmp_gt_u32 vcc, 256, v19
    v_bfe_u32 v12, v19, 1, 6
    v_and_b32 v13, 63, v19
    v_cndmask_b32 v12, v13, v12, vcc
    v_and_b32 v13, 1, v19
    v_cndmask_b32 v13, 0, v13, vcc
    v_lshrrev_b32 v19, 7, v19
    v_lshl_add_u32 v19, v19, 1, v13
    v_and_b32 v13, 15, v12
    v_lshl_add_u32 v19, v19, 4, v13
    v_mul_u32_u24 v19, 2304, v19
    v_lshrrev_b32 v12, 4, v12
    v_lshl_add_u32 v18, s4, 2, v18
    v_subrev_u32 v13, 36, v18
    v_min_u32 v18, v18, v13
    v_lshlrev_b32 v18, 5, v18
    v_lshl_add_u32 v18, v12, 3, v18
    v_add3_u32 v15, v18, v19, s12
    v_mov_b32 v8, v17
    v_mul_u32_u24 v18, 52429, v8
    v_lshrrev_b32 v18, 24, v18
    v_mul_u32_u24 v19, 320, v18
    v_sub_u32 v19, v8, v19
    v_cmp_gt_u32 vcc, 256, v19
    v_bfe_u32 v12, v19, 1, 6
    v_and_b32 v13, 63, v19
    v_cndmask_b32 v12, v13, v12, vcc
    v_and_b32 v13, 1, v19
    v_cndmask_b32 v13, 0, v13, vcc
    v_lshrrev_b32 v19, 7, v19
    v_lshl_add_u32 v19, v19, 1, v13
    v_and_b32 v13, 15, v12
    v_lshl_add_u32 v19, v19, 4, v13
    v_mul_u32_u24 v19, 2304, v19
    v_lshrrev_b32 v12, 4, v12
    v_lshl_add_u32 v18, s4, 2, v18
    v_subrev_u32 v13, 36, v18
    v_min_u32 v18, v18, v13
    v_lshlrev_b32 v18, 5, v18
    v_lshl_add_u32 v18, v12, 3, v18
    v_add3_u32 v16, v18, v19, s12
    s_branch L_r0
L_giveup:
    s_lshl_b32 s9, 0x10000, s101
    v_mov_b32 v11, s9
    s_mov_b64 exec, 1
    buffer_atomic_or v11, v5, s[16:19], s36 offen sc0
    s_waitcnt vmcnt(0)
    v_readfirstlane_b32 s14, v11
    s_mov_b64 exec, -1
    s_and_b32 s9, s14, 0xffff
    s_cmp_eq_u32 s9, 0xffff
    s_cbranch_scc1 L_r0
    s_branch L_next

L_fin:
L_end:
    s_endpgm
L_slow0:
    s_call_b64 s[60:61], L_fix0
    s_branch L_back0
L_slow1:
    s_call_b64 s[60:61], L_fix1
    s_branch L_back1
L_slow2:
    s_call_b64 s[60:61], L_fix2
    s_branch L_back2
L_slow3:
    s_call_b64 s[60:61], L_fix3
    s_branch L_back3
L_slow4:
    s_call_b64 s[60:61], L_fix4
    s_branch L_back4
L_slow5:
    s_call_b64 s[60:61], L_fix2
    s_branch L_back5
L_slow6:
    s_call_b64 s[60:61], L_fix3
    s_branch L_back6
L_slow7:
    s_call_b64 s[60:61], L_fix4
    s_branch L_back7
L_fix0:
    s_nop 7
    v_max3_f32 v220, v52, v53, v54
    v_max3_f32 v220, v220, v55, v56
    v_max3_f32 v220, v220, v57, v58
    v_max_f32 v220, v220, v59
    v_mov_b32 v221, v220
    s_nop 1
    v_permlane32_swap_b32 v220, v221
    v_max_f32 v220, v220, v221
    v_mov_b32 v221, v220
    s_nop 1
    v_permlane16_swap_b32 v220, v221
    v_max_f32 v220, v220, v221
    v_add_f32 v220, 0x40e00000, v220
    v_max_f32 v220, 0, v220
    v_sub_f32 v92, v92, v220
    v_sub_f32 v93, v93, v220
    v_sub_f32 v94, v94, v220
    v_sub_f32 v95, v95, v220
    v_sub_f32 v212, v52, v220
    v_sub_f32 v213, v53, v220
    v_sub_f32 v214, v54, v220
    v_sub_f32 v215, v55, v220
    v_sub_f32 v216, v56, v220
    v_sub_f32 v217, v57, v220
    v_sub_f32 v218, v58, v220
    v_sub_f32 v219, v59, v220
    v_exp_f32 v212, v212
    v_exp_f32 v213, v213
    v_exp_f32 v214, v214
    v_exp_f32 v215, v215
    v_exp_f32 v216, v216
    v_exp_f32 v217, v217
    v_exp_f32 v218, v218
    v_exp_f32 v219, v219
    v_exp_f32 v221, -v220
    v_cvt_pk_bf16_f32 v32, v212, v213
    v_cvt_pk_bf16_f32 v33, v214, v215
    v_cvt_pk_bf16_f32 v34, v216, v217
    v_cvt_pk_bf16_f32 v35, v218, v219
    v_mul_f32 v112, v112, v221
    v_mul_f32 v113, v113, v221
    v_mul_f32 v114, v114, v221
    v_mul_f32 v115, v115, v221
    v_mul_f32 v132, v132, v221
    v_mul_f32 v133, v133, v221
    v_mul_f32 v134, v134, v221
    v_mul_f32 v135, v135, v221
    v_mul_f32 v152, v152, v221
    v_mul_f32 v153, v153, v221
    v_mul_f32 v154, v154, v221
    v_mul_f32 v155, v155, v221
    v_mul_f32 v172, v172, v221
    v_mul_f32 v173, v173, v221
    v_mul_f32 v174, v174, v221
    v_mul_f32 v175, v175, v221
    v_accvgpr_read_b32 v212, a0
    v_accvgpr_read_b32 v213, a1
    v_accvgpr_read_b32 v214, a2
    v_accvgpr_read_b32 v215, a3
    v_mul_f32 v212, v212, v221
    v_mul_f32 v213, v213, v221
    v_mul_f32 v214, v214, v221
    v_mul_f32 v215, v215, v221
    v_accvgpr_write_b32 a0, v212
    v_accvgpr_write_b32 a1, v213
    v_accvgpr_write_b32 a2, v214
    v_accvgpr_write_b32 a3, v215
    v_accvgpr_read_b32 v212, a20
    v_accvgpr_read_b32 v213, a21
    v_accvgpr_read_b32 v214, a22
    v_accvgpr_read_b32 v215, a23
    v_mul_f32 v212, v212, v221
    v_mul_f32 v213, v213, v221
    v_mul_f32 v214, v214, v221
    v_mul_f32 v215, v215, v221
    v_accvgpr_write_b32 a20, v212
    v_accvgpr_write_b32 a21, v213
    v_accvgpr_write_b32 a22, v214
    v_accvgpr_write_b32 a23, v215
    v_accvgpr_read_b32 v212, a40
    v_accvgpr_read_b32 v213, a41
    v_accvgpr_read_b32 v214, a42
    v_accvgpr_read_b32 v215, a43
    v_mul_f32 v212, v212, v221
    v_mul_f32 v213, v213, v221
    v_mul_f32 v214, v214, v221
    v_mul_f32 v215, v215, v221
    v_accvgpr_write_b32 a40, v212
    v_accvgpr_write_b32 a41, v213
    v_accvgpr_write_b32 a42, v214
    v_accvgpr_write_b32 a43, v215
    v_accvgpr_read_b32 v212, a60
    v_accvgpr_read_b32 v213, a61
    v_accvgpr_read_b32 v214, a62
    v_accvgpr_read_b32 v215, a63
    v_mul_f32 v212, v212, v221
    v_mul_f32 v213, v213, v221
    v_mul_f32 v214, v214, v221
    v_mul_f32 v215, v215, v221
    v_accvgpr_write_b32 a60, v212
    v_accvgpr_write_b32 a61, v213
    v_accvgpr_write_b32 a62, v214
    v_accvgpr_write_b32 a63, v215
    v_accvgpr_read_b32 v212, a80
    v_accvgpr_read_b32 v213, a81
    v_accvgpr_read_b32 v214, a82
    v_accvgpr_read_b32 v215, a83
    v_mul_f32 v212, v212, v221
    v_mul_f32 v213, v213, v221
    v_mul_f32 v214, v214, v221
    v_mul_f32 v215, v215, v221
    v_accvgpr_write_b32 a80, v212
    v_accvgpr_write_b32 a81, v213
    v_accvgpr_write_b32 a82, v214
    v_accvgpr_write_b32 a83, v215
    s_nop 1
    s_setpc_b64 s[60:61]
L_fix1:
    s_nop 7
    v_max3_f32 v220, v60, v61, v62
    v_max3_f32 v220, v220, v63, v64
    v_max3_f32 v220, v220, v65, v66
    v_max_f32 v220, v220, v67
    v_mov_b32 v221, v220
    s_nop 1
    v_permlane32_swap_b32 v220, v221
    v_max_f32 v220, v220, v221
    v_mov_b32 v221, v220
    s_nop 1
    v_permlane16_swap_b32 v220, v221
    v_max_f32 v220, v220, v221
    v_add_f32 v220, 0x40e00000, v220
    v_max_f32 v220, 0, v220
    v_sub_f32 v96, v96, v220
    v_sub_f32 v97, v97, v220
    v_sub_f32 v98, v98, v220
    v_sub_f32 v99, v99, v220
    v_sub_f32 v212, v60, v220
    v_sub_f32 v213, v61, v220
    v_sub_f32 v214, v62, v220
    v_sub_f32 v215, v63, v220
    v_sub_f32 v216, v64, v220
    v_sub_f32 v217, v65, v220
    v_sub_f32 v218, v66, v220
    v_sub_f32 v219, v67, v220
    v_exp_f32 v212, v212
    v_exp_f32 v213, v213
    v_exp_f32 v214, v214
    v_exp_f32 v215, v215
    v_exp_f32 v216, v216
    v_exp_f32 v217, v217
    v_exp_f32 v218, v218
    v_exp_f32 v219, v219
    v_exp_f32 v221, -v220
    v_cvt_pk_bf16_f32 v36, v212, v213
    v_cvt_pk_bf16_f32 v37, v214, v215
    v_cvt_pk_bf16_f32 v38, v216, v217
    v_cvt_pk_bf16_f32 v39, v218, v219
    v_mul_f32 v116, v116, v221
    v_mul_f32 v117, v117, v221
    v_mul_f32 v118, v118, v221
    v_mul_f32 v119, v119, v221
    v_mul_f32 v136, v136, v221
    v_mul_f32 v137, v137, v221
    v_mul_f32 v138, v138, v221
    v_mul_f32 v139, v139, v221
    v_mul_f32 v156, v156, v221
    v_mul_f32 v157, v157, v221
    v_mul_f32 v158, v158, v221
    v_mul_f32 v159, v159, v221
    v_mul_f32 v176, v176, v221
    v_mul_f32 v177, v177, v221
    v_mul_f32 v178, v178, v221
    v_mul_f32 v179, v179, v221
    v_accvgpr_read_b32 v212, a4
    v_accvgpr_read_b32 v213, a5
    v_accvgpr_read_b32 v214, a6
    v_accvgpr_read_b32 v215, a7
    v_mul_f32 v212, v212, v221
    v_mul_f32 v213, v213, v221
    v_mul_f32 v214, v214, v221
    v_mul_f32 v215, v215, v221
    v_accvgpr_write_b32 a4, v212
    v_accvgpr_write_b32 a5, v213
    v_accvgpr_write_b32 a6, v214
    v_accvgpr_write_b32 a7, v215
    v_accvgpr_read_b32 v212, a24
    v_accvgpr_read_b32 v213, a25
    v_accvgpr_read_b32 v214, a26
    v_accvgpr_read_b32 v215, a27
    v_mul_f32 v212, v212, v221
    v_mul_f32 v213, v213, v221
    v_mul_f32 v214, v214, v221
    v_mul_f32 v215, v215, v221
    v_accvgpr_write_b32 a24, v212
    v_accvgpr_write_b32 a25, v213
    v_accvgpr_write_b32 a26, v214
    v_accvgpr_write_b32 a27, v215
    v_accvgpr_read_b32 v212, a44
    v_accvgpr_read_b32 v213, a45
    v_accvgpr_read_b32 v214, a46
    v_accvgpr_read_b32 v215, a47
    v_mul_f32 v212, v212, v221
    v_mul_f32 v213, v213, v221
    v_mul_f32 v214, v214, v221
    v_mul_f32 v215, v215, v221
    v_accvgpr_write_b32 a44, v212
    v_accvgpr_write_b32 a45, v213
    v_accvgpr_write_b32 a46, v214
    v_accvgpr_write_b32 a47, v215
    v_accvgpr_read_b32 v212, a64
    v_accvgpr_read_b32 v213, a65
    v_accvgpr_read_b32 v214, a66
    v_accvgpr_read_b32 v215, a67
    v_mul_f32 v212, v212, v221
    v_mul_f32 v213, v213, v221
    v_mul_f32 v214, v214, v221
    v_mul_f32 v215, v215, v221
    v_accvgpr_write_b32 a64, v212
    v_accvgpr_write_b32 a65, v213
    v_accvgpr_write_b32 a66, v214
    v_accvgpr_write_b32 a67, v215
    v_accvgpr_read_b32 v212, a84
    v_accvgpr_read_b32 v213, a85
    v_accvgpr_read_b32 v214, a86
    v_accvgpr_read_b32 v215, a87
    v_mul_f32 v212, v212, v221
    v_mul_f32 v213, v213, v221
    v_mul_f32 v214, v214, v221
    v_mul_f32 v215, v215, v221
    v_accvgpr_write_b32 a84, v212
    v_accvgpr_write_b32 a85, v213
    v_accvgpr_write_b32 a86, v214
    v_accvgpr_write_b32 a87, v215
    s_nop 1
    s_setpc_b64 s[60:61]
L_fix2:
    s_nop 7
    v_max3_f32 v220, v68, v69, v70
    v_max3_f32 v220, v220, v71, v72
    v_max3_f32 v220, v220, v73, v74
    v_max_f32 v220, v220, v75
    v_mov_b32 v221, v220
    s_nop 1
    v_permlane32_swap_b32 v220, v221
    v_max_f32 v220, v220, v221
    v_mov_b32 v221, v220
    s_nop 1
    v_permlane16_swap_b32 v220, v221
    v_max_f32 v220, v220, v221
    v_add_f32 v220, 0x40e00000, v220
    v_max_f32 v220, 0, v220
    v_sub_f32 v100, v100, v220
    v_sub_f32 v101, v101, v220
    v_sub_f32 v102, v102, v220
    v_sub_f32 v103, v103, v220
    v_sub_f32 v212, v68, v220
    v_sub_f32 v213, v69, v220
    v_sub_f32 v214, v70, v220
    v_sub_f32 v215, v71, v220
    v_sub_f32 v216, v72, v220
    v_sub_f32 v217, v73, v220
    v_sub_f32 v218, v74, v220
    v_sub_f32 v219, v75, v220
    v_exp_f32 v212, v212
    v_exp_f32 v213, v213
    v_exp_f32 v214, v214
    v_exp_f32 v215, v215
    v_exp_f32 v216, v216
    v_exp_f32 v217, v217
    v_exp_f32 v218, v218
    v_exp_f32 v219, v219
    v_exp_f32 v221, -v220
    v_cvt_pk_bf16_f32 v40, v212, v213
    v_cvt_pk_bf16_f32 v41, v214, v215
    v_cvt_pk_bf16_f32 v42, v216, v217
    v_cvt_pk_bf16_f32 v43, v218, v219
    v_mul_f32 v120, v120, v221
    v_mul_f32 v121, v121, v221
    v_mul_f32 v122, v122, v221
    v_mul_f32 v123, v123, v221
    v_mul_f32 v140, v140, v221
    v_mul_f32 v141, v141, v221
    v_mul_f32 v142, v142, v221
    v_mul_f32 v143, v143, v221
    v_mul_f32 v160, v160, v221
    v_mul_f32 v161, v161, v221
    v_mul_f32 v162, v162, v221
    v_mul_f32 v163, v163, v221
    v_mul_f32 v180, v180, v221
    v_mul_f32 v181, v181, v221
    v_mul_f32 v182, v182, v221
    v_mul_f32 v183, v183, v221
    v_accvgpr_read_b32 v212, a8
    v_accvgpr_read_b32 v213, a9
    v_accvgpr_read_b32 v214, a10
    v_accvgpr_read_b32 v215, a11
    v_mul_f32 v212, v212, v221
    v_mul_f32 v213, v213, v221
    v_mul_f32 v214, v214, v221
    v_mul_f32 v215, v215, v221
    v_accvgpr_write_b32 a8, v212
    v_accvgpr_write_b32 a9, v213
    v_accvgpr_write_b32 a10, v214
    v_accvgpr_write_b32 a11, v215
    v_accvgpr_read_b32 v212, a28
    v_accvgpr_read_b32 v213, a29
    v_accvgpr_read_b32 v214, a30
    v_accvgpr_read_b32 v215, a31
    v_mul_f32 v212, v212, v221
    v_mul_f32 v213, v213, v221
    v_mul_f32 v214, v214, v221
    v_mul_f32 v215, v215, v221
    v_accvgpr_write_b32 a28, v212
    v_accvgpr_write_b32 a29, v213
    v_accvgpr_write_b32 a30, v214
    v_accvgpr_write_b32 a31, v215
    v_accvgpr_read_b32 v212, a48
    v_accvgpr_read_b32 v213, a49
    v_accvgpr_read_b32 v214, a50
    v_accvgpr_read_b32 v215, a51
    v_mul_f32 v212, v212, v221
    v_mul_f32 v213, v213, v221
    v_mul_f32 v214, v214, v221
    v_mul_f32 v215, v215, v221
    v_accvgpr_write_b32 a48, v212
    v_accvgpr_write_b32 a49, v213
    v_accvgpr_write_b32 a50, v214
    v_accvgpr_write_b32 a51, v215
    v_accvgpr_read_b32 v212, a68
    v_accvgpr_read_b32 v213, a69
    v_accvgpr_read_b32 v214, a70
    v_accvgpr_read_b32 v215, a71
    v_mul_f32 v212, v212, v221
    v_mul_f32 v213, v213, v221
    v_mul_f32 v214, v214, v221
    v_mul_f32 v215, v215, v221
    v_accvgpr_write_b32 a68, v212
    v_accvgpr_write_b32 a69, v213
    v_accvgpr_write_b32 a70, v214
    v_accvgpr_write_b32 a71, v215
    v_accvgpr_read_b32 v212, a88
    v_accvgpr_read_b32 v213, a89
    v_accvgpr_read_b32 v214, a90
    v_accvgpr_read_b32 v215, a91
    v_mul_f32 v212, v212, v221
    v_mul_f32 v213, v213, v221
    v_mul_f32 v214, v214, v221
    v_mul_f32 v215, v215, v221
    v_accvgpr_write_b32 a88, v212
    v_accvgpr_write_b32 a89, v213
    v_accvgpr_write_b32 a90, v214
    v_accvgpr_write_b32 a91, v215
    s_nop 1
    s_setpc_b64 s[60:61]
L_fix3:
    s_nop 7
    v_max3_f32 v220, v76, v77, v78
    v_max3_f32 v220, v220, v79, v80
    v_max3_f32 v220, v220, v81, v82
    v_max_f32 v220, v220, v83
    v_mov_b32 v221, v220
    s_nop 1
    v_permlane32_swap_b32 v220, v221
    v_max_f32 v220, v220, v221
    v_mov_b32 v221, v220
    s_nop 1
    v_permlane16_swap_b32 v220, v221
    v_max_f32 v220, v220, v221
    v_add_f32 v220, 0x40e00000, v220
    v_max_f32 v220, 0, v220
    v_sub_f32 v104, v104, v220
    v_sub_f32 v105, v105, v220
    v_sub_f32 v106, v106, v220
    v_sub_f32 v107, v107, v220
    v_sub_f32 v212, v76, v220
    v_sub_f32 v213, v77, v220
    v_sub_f32 v214, v78, v220
    v_sub_f32 v215, v79, v220
    v_sub_f32 v216, v80, v220
    v_sub_f32 v217, v81, v220
    v_sub_f32 v218, v82, v220
    v_sub_f32 v219, v83, v220
    v_exp_f32 v212, v212
    v_exp_f32 v213, v213
    v_exp_f32 v214, v214
    v_exp_f32 v215, v215
    v_exp_f32 v216, v216
    v_exp_f32 v217, v217
    v_exp_f32 v218, v218
    v_exp_f32 v219, v219
    v_exp_f32 v221, -v220
    v_cvt_pk_bf16_f32 v44, v212, v213
    v_cvt_pk_bf16_f32 v45, v214, v215
    v_cvt_pk_bf16_f32 v46, v216, v217
    v_cvt_pk_bf16_f32 v47, v218, v219
    v_mul_f32 v124, v124, v221
    v_mul_f32 v125, v125, v221
    v_mul_f32 v126, v126, v221
    v_mul_f32 v127, v127, v221
    v_mul_f32 v144, v144, v221
    v_mul_f32 v145, v145, v221
    v_mul_f32 v146, v146, v221
    v_mul_f32 v147, v147, v221
    v_mul_f32 v164, v164, v221
    v_mul_f32 v165, v165, v221
    v_mul_f32 v166, v166, v221
    v_mul_f32 v167, v167, v221
    v_mul_f32 v184, v184, v221
    v_mul_f32 v185, v185, v221
    v_mul_f32 v186, v186, v221
    v_mul_f32 v187, v187, v221
    v_accvgpr_read_b32 v212, a12
    v_accvgpr_read_b32 v213, a13
    v_accvgpr_read_b32 v214, a14
    v_accvgpr_read_b32 v215, a15
    v_mul_f32 v212, v212, v221
    v_mul_f32 v213, v213, v221
    v_mul_f32 v214, v214, v221
    v_mul_f32 v215, v215, v221
    v_accvgpr_write_b32 a12, v212
    v_accvgpr_write_b32 a13, v213
    v_accvgpr_write_b32 a14, v214
    v_accvgpr_write_b32 a15, v215
    v_accvgpr_read_b32 v212, a32
    v_accvgpr_read_b32 v213, a33
    v_accvgpr_read_b32 v214, a34
    v_accvgpr_read_b32 v215, a35
    v_mul_f32 v212, v212, v221
    v_mul_f32 v213, v213, v221
    v_mul_f32 v214, v214, v221
    v_mul_f32 v215, v215, v221
    v_accvgpr_write_b32 a32, v212
    v_accvgpr_write_b32 a33, v213
    v_accvgpr_write_b32 a34, v214
    v_accvgpr_write_b32 a35, v215
    v_accvgpr_read_b32 v212, a52
    v_accvgpr_read_b32 v213, a53
    v_accvgpr_read_b32 v214, a54
    v_accvgpr_read_b32 v215, a55
    v_mul_f32 v212, v212, v221
    v_mul_f32 v213, v213, v221
    v_mul_f32 v214, v214, v221
    v_mul_f32 v215, v215, v221
    v_accvgpr_write_b32 a52, v212
    v_accvgpr_write_b32 a53, v213
    v_accvgpr_write_b32 a54, v214
    v_accvgpr_write_b32 a55, v215
    v_accvgpr_read_b32 v212, a72
    v_accvgpr_read_b32 v213, a73
    v_accvgpr_read_b32 v214, a74
    v_accvgpr_read_b32 v215, a75
    v_mul_f32 v212, v212, v221
    v_mul_f32 v213, v213, v221
    v_mul_f32 v214, v214, v221
    v_mul_f32 v215, v215, v221
    v_accvgpr_write_b32 a72, v212
    v_accvgpr_write_b32 a73, v213
    v_accvgpr_write_b32 a74, v214
    v_accvgpr_write_b32 a75, v215
    v_accvgpr_read_b32 v212, a92
    v_accvgpr_read_b32 v213, a93
    v_accvgpr_read_b32 v214, a94
    v_accvgpr_read_b32 v215, a95
    v_mul_f32 v212, v212, v221
    v_mul_f32 v213, v213, v221
    v_mul_f32 v214, v214, v221
    v_mul_f32 v215, v215, v221
    v_accvgpr_write_b32 a92, v212
    v_accvgpr_write_b32 a93, v213
    v_accvgpr_write_b32 a94, v214
    v_accvgpr_write_b32 a95, v215
    s_nop 1
    s_setpc_b64 s[60:61]
L_fix4:
    s_nop 7
    v_max3_f32 v220, v84, v85, v86
    v_max3_f32 v220, v220, v87, v88
    v_max3_f32 v220, v220, v89, v90
    v_max_f32 v220, v220, v91
    v_mov_b32 v221, v220
    s_nop 1
    v_permlane32_swap_b32 v220, v221
    v_max_f32 v220, v220, v221
    v_mov_b32 v221, v220
    s_nop 1
    v_permlane16_swap_b32 v220, v221
    v_max_f32 v220, v220, v221
    v_add_f32 v220, 0x40e00000, v220
    v_max_f32 v220, 0, v220
    v_sub_f32 v108, v108, v220
    v_sub_f32 v109, v109, v220
    v_sub_f32 v110, v110, v220
    v_sub_f32 v111, v111, v220
    v_sub_f32 v212, v84, v220
    v_sub_f32 v213, v85, v220
    v_sub_f32 v214, v86, v220
    v_sub_f32 v215, v87, v220
    v_sub_f32 v216, v88, v220
    v_sub_f32 v217, v89, v220
    v_sub_f32 v218, v90, v220
    v_sub_f32 v219, v91, v220
    v_exp_f32 v212, v212
    v_exp_f32 v213, v213
    v_exp_f32 v214, v214
    v_exp_f32 v215, v215
    v_exp_f32 v216, v216
    v_exp_f32 v217, v217
    v_exp_f32 v218, v218
    v_exp_f32 v219, v219
    v_exp_f32 v221, -v220
    v_cvt_pk_bf16_f32 v48, v212, v213
    v_cvt_pk_bf16_f32 v49, v214, v215
    v_cvt_pk_bf16_f32 v50, v216, v217
    v_cvt_pk_bf16_f32 v51, v218, v219
    v_mul_f32 v128, v128, v221
    v_mul_f32 v129, v129, v221
    v_mul_f32 v130, v130, v221
    v_mul_f32 v131, v131, v221
    v_mul_f32 v148, v148, v221
    v_mul_f32 v149, v149, v221
    v_mul_f32 v150, v150, v221
    v_mul_f32 v151, v151, v221
    v_mul_f32 v168, v168, v221
    v_mul_f32 v169, v169, v221
    v_mul_f32 v170, v170, v221
    v_mul_f32 v171, v171, v221
    v_mul_f32 v188, v188, v221
    v_mul_f32 v189, v189, v221
    v_mul_f32 v190, v190, v221
    v_mul_f32 v191, v191, v221
    v_accvgpr_read_b32 v212, a16
    v_accvgpr_read_b32 v213, a17
    v_accvgpr_read_b32 v214, a18
    v_accvgpr_read_b32 v215, a19
    v_mul_f32 v212, v212, v221
    v_mul_f32 v213, v213, v221
    v_mul_f32 v214, v214, v221
    v_mul_f32 v215, v215, v221
    v_accvgpr_write_b32 a16, v212
    v_accvgpr_write_b32 a17, v213
    v_accvgpr_write_b32 a18, v214
    v_accvgpr_write_b32 a19, v215
    v_accvgpr_read_b32 v212, a36
    v_accvgpr_read_b32 v213, a37
    v_accvgpr_read_b32 v214, a38
    v_accvgpr_read_b32 v215, a39
    v_mul_f32 v212, v212, v221
    v_mul_f32 v213, v213, v221
    v_mul_f32 v214, v214, v221
    v_mul_f32 v215, v215, v221
    v_accvgpr_write_b32 a36, v212
    v_accvgpr_write_b32 a37, v213
    v_accvgpr_write_b32 a38, v214
    v_accvgpr_write_b32 a39, v215
    v_accvgpr_read_b32 v212, a56
    v_accvgpr_read_b32 v213, a57
    v_accvgpr_read_b32 v214, a58
    v_accvgpr_read_b32 v215, a59
    v_mul_f32 v212, v212, v221
    v_mul_f32 v213, v213, v221
    v_mul_f32 v214, v214, v221
    v_mul_f32 v215, v215, v221
    v_accvgpr_write_b32 a56, v212
    v_accvgpr_write_b32 a57, v213
    v_accvgpr_write_b32 a58, v214
    v_accvgpr_write_b32 a59, v215
    v_accvgpr_read_b32 v212, a76
    v_accvgpr_read_b32 v213, a77
    v_accvgpr_read_b32 v214, a78
    v_accvgpr_read_b32 v215, a79
    v_mul_f32 v212, v212, v221
    v_mul_f32 v213, v213, v221
    v_mul_f32 v214, v214, v221
    v_mul_f32 v215, v215, v221
    v_accvgpr_write_b32 a76, v212
    v_accvgpr_write_b32 a77, v213
    v_accvgpr_write_b32 a78, v214
    v_accvgpr_write_b32 a79, v215
    v_accvgpr_read_b32 v212, a96
    v_accvgpr_read_b32 v213, a97
    v_accvgpr_read_b32 v214, a98
    v_accvgpr_read_b32 v215, a99
    v_mul_f32 v212, v212, v221
    v_mul_f32 v213, v213, v221
    v_mul_f32 v214, v214, v221
    v_mul_f32 v215, v215, v221
    v_accvgpr_write_b32 a96, v212
    v_accvgpr_write_b32 a97, v213
    v_accvgpr_write_b32 a98, v214
    v_accvgpr_write_b32 a99, v215
    s_nop 1
    s_setpc_b64 s[60:61]
L_code_end:
.section .rodata,"a"
.p2align 6
.amdhsa_kernel concat_heads__gqa_block_cached__gqa_block_cached__near_ridge_kernel
  .amdhsa_next_free_vgpr 512
  .amdhsa_next_free_sgpr 102
  .amdhsa_accum_offset 256
  .amdhsa_group_segment_fixed_size 0
  .amdhsa_kernarg_size 104
  .amdhsa_user_sgpr_count 2
  .amdhsa_user_sgpr_kernarg_segment_ptr 1
  .amdhsa_system_sgpr_workgroup_id_x 1
.end_amdhsa_kernel
```
